```python
import torch

def _softmax(x, axis=-1):
    return torch.softmax(x, dim=axis)
def _gelu(x):
    return torch.nn.functional.gelu(x, approximate="tanh")
def _silu(x):
    return torch.nn.functional.silu(x)
def _sigmoid(x):
    return torch.sigmoid(x)
def _layernorm(x, axis=-1, eps=1e-5):
    m = x.mean(dim=axis, keepdim=True)
    v = x.var(dim=axis, keepdim=True, unbiased=False)
    return (x - m) / torch.sqrt(v + eps)
def _scatter_add(tgt, idx, src, axis=0):
    return tgt.clone().index_add_(axis, idx, src)
def _segment_sum(src, seg, n):
    out = torch.zeros((n,) + src.shape[1:], dtype=src.dtype)
    return out.index_add_(0, seg, src)
def _pad(x, pw):
    flat = tuple(v for pair in reversed(pw) for v in pair)
    return torch.nn.functional.pad(x, flat)

kernel_name = 'sequential_preLN__spectral_gfnet__mixer_token_mlp__prompt'

def setup_inputs():

    _w = (lambda a: (lambda t: t.to(torch.bfloat16) if t.is_floating_point() else t)(torch.as_tensor(a)))
    def _A_setup():
        B, S, D = 1, 2048, 512
        Df = D // 2 + 1
        return {
            "x": _w((lambda *s: torch.randn(*s, dtype=torch.bfloat16) * 0.05)(B, S, D)),
            "w_r": _w((lambda *s: torch.randn(*s, dtype=torch.bfloat16) * 0.2)(S, Df) * 0.02),
            "w_i": _w((lambda *s: torch.randn(*s, dtype=torch.bfloat16) * 0.2)(S, Df) * 0.02),
        }
    _A_in = _A_setup()

    def _B_setup():
        B, S, D, F = 1, 2048, 512, 1376
        return {
            "x": _w((lambda *s: torch.randn(*s, dtype=torch.bfloat16) * 0.05)(B, S, D)),
            "w1": _w((lambda *s: torch.randn(*s, dtype=torch.bfloat16) * 0.4)(S, F) * (S ** -0.5)),
            "b1": _w((lambda *s: torch.randn(*s, dtype=torch.bfloat16) * 3.2)(F) * 0.02),
            "w2": _w((lambda *s: torch.randn(*s, dtype=torch.bfloat16) * 0.2)(F, S) * (F ** -0.5)),
            "b2": _w((lambda *s: torch.randn(*s, dtype=torch.bfloat16) * 0.4)(S) * 0.02),
        }
    _B_in = _B_setup()

    return {
        "A_x": _A_in["x"],
        "A_w_r": _A_in["w_r"],
        "A_w_i": _A_in["w_i"],
        "B_x": _B_in["x"],
        "B_w1": _B_in["w1"],
        "B_b1": _B_in["b1"],
        "B_w2": _B_in["w2"],
        "B_b2": _B_in["b2"],
    }

def reference(A_x, A_w_r, A_w_i, B_x, B_w1, B_b1, B_w2, B_b2):
    def _A_ref(x, w_r, w_i):
        B, S, D = x.shape
        X = (lambda x, axes=(-2,-1): torch.fft.rfft2(x.float(), dim=axes))(x, axes=(-2, -1))
        W = w_r + 1j * w_i
        X = X * W
        y = (lambda x, s, axes=(-2,-1): torch.fft.irfft2(x, s=s, dim=axes).to(torch.bfloat16))(X, (S, D), axes=(-2, -1))
        return y

    def _B_ref(x, w1, b1, w2, b2):
        B, S, D = x.shape
        h = _layernorm(x, axis=-1)
        u = torch.einsum("bsd,sf->bdf", h, w1) + b1
        u = _gelu(u)
        y = torch.einsum("bdf,fs->bds", u, w2) + b2
        return (lambda x, *d: x.permute(*d))(y, 0, 2, 1)

    x = A_x
    h = x + _A_ref(_layernorm(x, axis=-1), A_w_r, A_w_i)
    h2 = h + _B_ref(_layernorm(h, axis=-1), B_w1, B_b1, B_w2, B_b2)
    return h2
```

```asm
; @launch kernel=k1_kernel grid=(256,1,1) block=(256,1,1) lds=17408
; @launch kernel=k2_kernel grid=(256,1,1) block=(256,1,1) lds=34816
; @launch kernel=k3_kernel grid=(256,1,1) block=(256,1,1) lds=18944
; @launch kernel=sequential_preLN__spectral_gfnet__mixer_token_mlp__prompt_kernel grid=(256,1,1) block=(256,1,1) lds=81920
.amdgcn_target "amdgcn-amd-amdhsa--gfx950"
.text
.globl k1_kernel
.p2align 8
.type k1_kernel,@function
k1_kernel:
    s_cmp_ge_u32 s2, 256
    s_cbranch_scc1 K1_END
    s_load_dwordx2 s[4:5], s[0:1], 0
    s_load_dwordx2 s[6:7], s[0:1], 80
    s_load_dwordx4 s[28:31], s[0:1], 8
    v_and_b32 v1, 63, v0
    v_lshrrev_b32 v2, 6, v0
    s_lshr_b32 s12, s2, 3
    v_readfirstlane_b32 s3, v2
    s_and_b32 s13, s2, 7
    s_lshl_b32 s13, s13, 8
    s_add_u32 s13, s13, s12
    v_lshlrev_b32 v3, 4, v1
    s_lshl_b32 s14, s3, 6
    s_add_u32 s13, s13, s14
    s_lshl_b32 s13, s13, 10
    s_add_u32 s14, s13, 32768
    s_and_b32 s56, s2, 7
    s_lshl_b32 s56, s56, 8
    s_lshr_b32 s57, s2, 5
    s_lshl_b32 s57, s57, 3
    s_add_u32 s56, s56, s57
    s_bfe_u32 s63, s2, 0x20003
    s_lshl_b32 s57, s63, 1
    s_add_u32 s23, s56, s57
    s_lshl_b32 s57, s3, 1
    s_add_u32 s56, s56, s57
    s_mul_i32 s56, s56, 514
    s_lshl_b32 s57, s63, 7
    s_add_u32 s56, s56, s57
    s_add_u32 s57, s56, 32896
    s_add_u32 s58, s56, 65792
    s_add_u32 s59, s56, 98688
    v_lshlrev_b32 v158, 1, v1
    v_bfe_u32 v160, v1, 2, 2
    v_bfe_u32 v161, v1, 4, 1
    v_lshl_add_u32 v160, v160, 6, v161
    v_add_u32 v160, s23, v160
    v_sub_u32 v161, 2048, v160
    v_and_b32 v161, 2047, v161
    v_and_b32 v159, 1, v1
    v_cmp_eq_u32 vcc, 1, v159
    s_nop 1
    v_cndmask_b32 v160, v160, v161, vcc
    v_mul_u32_u24 v160, 514, v160
    v_and_b32 v159, 2, v1
    v_lshl_add_u32 v160, v159, 8, v160
    s_cmp_eq_u32 s3, 3
    s_cselect_b32 s26, 32, 0
    v_mov_b32 v173, 0x40000000
    v_cmp_gt_u32 vcc, s26, v1
    s_nop 1
    v_cndmask_b32 v160, v173, v160, vcc
    s_waitcnt lgkmcnt(0)
    s_mov_b32 s8, s4
    s_and_b32 s9, s5, 0xffff
    s_mov_b32 s10, 0x200000
    s_mov_b32 s11, 0x20000
    buffer_load_dwordx4 v[4:7], v3, s[8:11], s13 offen
    buffer_load_dwordx4 v[8:11], v3, s[8:11], s14 offen
    s_mov_b32 s32, s28
    s_and_b32 s33, s29, 0xffff
    s_mov_b32 s34, 0x101000
    s_mov_b32 s35, 0x20000
    s_mov_b32 s36, s30
    s_and_b32 s37, s31, 0xffff
    s_mov_b32 s38, 0x101000
    s_mov_b32 s39, 0x20000
    s_getpc_b64 s[48:49]
CPF_PC:
    s_add_u32 s48, s48, k2_kernel-CPF_PC
    s_addc_u32 s49, s49, 0
    s_and_b32 s49, s49, 0xffff
    s_mov_b32 s50, CODE_END-k2_kernel
    s_mov_b32 s51, 0x20000
    s_lshr_b32 s52, s2, 3
    s_lshl_b32 s52, s52, 2
    s_add_u32 s52, s52, s3
    s_lshl_b32 s52, s52, 12
    v_lshlrev_b32 v125, 6, v1
    buffer_load_dword v124, v125, s[48:51], s52 offen
    s_mov_b32 s16, s6
    s_and_b32 s17, s7, 0xffff
    s_mov_b32 s18, 0x208000
    s_mov_b32 s19, 0x20000
    s_add_u32 s40, s6, 0x300000
    s_addc_u32 s41, s7, 0
    s_and_b32 s41, s41, 0xffff
    s_mov_b32 s42, 0x204000
    s_mov_b32 s43, 0x20000
    s_mul_i32 s15, s2, 8320
    s_lshr_b32 s60, s2, 6
    s_lshl_b32 s60, s60, 11
    s_bfe_u32 s61, s2, 0x10002
    s_lshl_b32 s61, s61, 10
    s_add_u32 s60, s60, s61
    s_and_b32 s61, s2, 3
    s_lshl_b32 s61, s61, 8
    s_add_u32 s60, s60, s61
    s_bfe_u32 s61, s2, 0x10005
    s_lshl_b32 s61, s61, 7
    s_add_u32 s60, s60, s61
    s_lshl_b32 s61, s63, 5
    s_add_u32 s29, s60, s61
    s_lshl_b32 s61, s63, 19
    s_add_u32 s60, s60, s61
    v_mul_u32_u24 v170, 144, v1
    s_lshl_b32 s61, s3, 5
    s_add_u32 s61, s61, 8192
    v_add_u32 v170, s61, v170
    v_lshrrev_b32 v159, 3, v1
    s_lshl_b32 s61, s3, 4
    v_add_u32 v159, s61, v159
    v_mul_u32_u24 v171, 144, v159
    v_and_b32 v172, 7, v1
    v_lshlrev_b32 v172, 4, v172
    v_add_u32 v171, v171, v172
    v_add_u32 v171, 8192, v171
    v_lshl_add_u32 v159, v159, 13, v172
    v_lshrrev_b32 v161, 2, v1
    v_lshlrev_b32 v161, 2, v161
    v_and_b32 v172, 2, v1
    v_lshlrev_b32 v172, 12, v172
    v_sub_u32 v161, v161, v172
    v_add_u32 v161, 0x202000, v161
    v_and_b32 v172, 1, v1
    v_cmp_eq_u32 vcc, 0, v172
    s_nop 1
    v_cndmask_b32 v161, v173, v161, vcc
    v_cmp_gt_u32 vcc, s26, v1
    s_nop 1
    v_cndmask_b32 v161, v173, v161, vcc
    v_lshrrev_b32 v12, 4, v1
    v_and_b32 v13, 15, v1
    v_cvt_f32_u32 v14, v12
    v_cvt_f32_u32 v15, v13
    v_mul_f32 v96, v15, v14
    v_mul_f32 v96, 0x3e000000, v96
    v_fmamk_f32 v97, v15, 0x3d000000, v96
    v_fmamk_f32 v98, v15, 0x3d800000, v96
    v_fmamk_f32 v99, v15, 0x3dc00000, v96
    v_cos_f32 v100, v96
    v_sin_f32 v104, v96
    v_cos_f32 v101, v97
    v_sin_f32 v105, v97
    v_cos_f32 v102, v98
    v_sin_f32 v106, v98
    v_cos_f32 v103, v99
    v_sin_f32 v107, v99
    v_and_b32 v108, 1, v1
    v_mul_u32_u24 v108, 0x8000, v108
    v_lshl_or_b32 v108, v108, 16, v108
    v_cvt_pk_bf16_f32 v16, v100, v101
    v_cvt_pk_bf16_f32 v17, v102, v103
    v_cvt_pk_bf16_f32 v20, -v104, -v105
    v_cvt_pk_bf16_f32 v21, -v106, -v107
    v_xor_b32 v18, v16, v108
    v_xor_b32 v19, v17, v108
    v_xor_b32 v22, v20, v108
    v_xor_b32 v23, v21, v108
    v_xor_b32 v24, 0x80000000, v16
    v_xor_b32 v25, 0x80000000, v17
    v_xor_b32 v26, 0x80000000, v18
    v_xor_b32 v27, 0x80000000, v19
    v_xor_b32 v28, 0x80000000, v20
    v_xor_b32 v29, 0x80000000, v21
    v_xor_b32 v30, 0x80000000, v22
    v_xor_b32 v31, 0x80000000, v23
    v_mul_f32 v96, 0x3b000000, v15
    v_add_f32 v97, 0x3d000000, v96
    v_mul_f32 v98, 4.0, v14
    v_add_f32 v99, 0x3f800000, v98
    v_add_f32 v100, 0x40000000, v98
    v_add_f32 v101, 0x40400000, v98
    v_mul_f32 v102, v96, v98
    v_mul_f32 v103, v96, v99
    v_mul_f32 v104, v96, v100
    v_mul_f32 v105, v96, v101
    v_mul_f32 v106, v97, v98
    v_mul_f32 v107, v97, v99
    v_mul_f32 v108, v97, v100
    v_mul_f32 v109, v97, v101
    v_cos_f32 v32, v102
    v_sin_f32 v40, v102
    v_cos_f32 v33, v103
    v_sin_f32 v41, v103
    v_cos_f32 v34, v104
    v_sin_f32 v42, v104
    v_cos_f32 v35, v105
    v_sin_f32 v43, v105
    v_cos_f32 v36, v106
    v_sin_f32 v44, v106
    v_cos_f32 v37, v107
    v_sin_f32 v45, v107
    v_cos_f32 v38, v108
    v_sin_f32 v46, v108
    v_cos_f32 v39, v109
    v_sin_f32 v47, v109
    v_lshrrev_b32 v96, 1, v13
    v_cvt_f32_u32 v96, v96
    v_mul_f32 v96, 0x3d800000, v96
    v_and_b32 v97, 1, v13
    v_cvt_f32_u32 v97, v97
    v_mul_f32 v97, 0x3e800000, v97
    v_fma_f32 v102, v96, v98, v97
    v_fma_f32 v103, v96, v99, v97
    v_fma_f32 v104, v96, v100, v97
    v_fma_f32 v105, v96, v101, v97
    v_cos_f32 v106, v102
    v_sin_f32 v110, v102
    v_cos_f32 v107, v103
    v_sin_f32 v111, v103
    v_cos_f32 v108, v104
    v_sin_f32 v112, v104
    v_cos_f32 v109, v105
    v_sin_f32 v113, v105
    v_cvt_pk_bf16_f32 v48, v106, v110
    v_cvt_pk_bf16_f32 v49, v107, v111
    v_cvt_pk_bf16_f32 v50, v108, v112
    v_cvt_pk_bf16_f32 v51, v109, v113
    v_mov_b32 v52, 0x3f80
    v_mov_b32 v53, 0xbf80
    v_mov_b32 v54, 0x3f80
    v_mov_b32 v55, 0xbf80
    s_lshl_b32 s20, s3, 3
    v_lshlrev_b32 v56, 5, v13
    v_lshl_add_u32 v56, v12, 11, v56
    v_add_u32 v56, s20, v56
    s_mov_b64 s[30:31], 1
    s_lshl_b32 s22, s3, 11
    v_add_u32 v58, s22, v3
    v_lshlrev_b32 v59, 3, v1
    v_add_u32 v59, s22, v59
    s_waitcnt vmcnt(1)
    buffer_load_ushort v128, v158, s[32:35], s56 offen offset:0
    buffer_load_ushort v129, v158, s[36:39], s56 offen offset:0
    buffer_load_ushort v136, v158, s[32:35], s56 offen offset:514
    buffer_load_ushort v137, v158, s[36:39], s56 offen offset:514
    buffer_load_ushort v130, v158, s[32:35], s57 offen offset:0
    buffer_load_ushort v131, v158, s[36:39], s57 offen offset:0
    buffer_load_ushort v138, v158, s[32:35], s57 offen offset:514
    buffer_load_ushort v139, v158, s[36:39], s57 offen offset:514
    buffer_load_ushort v132, v158, s[32:35], s58 offen offset:0
    buffer_load_ushort v133, v158, s[36:39], s58 offen offset:0
    buffer_load_ushort v140, v158, s[32:35], s58 offen offset:514
    buffer_load_ushort v141, v158, s[36:39], s58 offen offset:514
    buffer_load_ushort v134, v158, s[32:35], s59 offen offset:0
    buffer_load_ushort v135, v158, s[36:39], s59 offen offset:0
    buffer_load_ushort v142, v158, s[32:35], s59 offen offset:514
    buffer_load_ushort v143, v158, s[36:39], s59 offen offset:514
    buffer_load_ushort v144, v160, s[32:35], 0 offen
    buffer_load_ushort v145, v160, s[36:39], 0 offen
    v_lshlrev_b32 v64, 16, v4
    v_and_b32 v65, 0xffff0000, v4
    v_lshlrev_b32 v66, 16, v5
    v_and_b32 v67, 0xffff0000, v5
    v_lshlrev_b32 v68, 16, v6
    v_and_b32 v69, 0xffff0000, v6
    v_lshlrev_b32 v70, 16, v7
    v_and_b32 v71, 0xffff0000, v7
    v_lshlrev_b32 v72, 16, v8
    v_and_b32 v73, 0xffff0000, v8
    v_lshlrev_b32 v74, 16, v9
    v_and_b32 v75, 0xffff0000, v9
    v_lshlrev_b32 v76, 16, v10
    v_and_b32 v77, 0xffff0000, v10
    v_lshlrev_b32 v78, 16, v11
    v_and_b32 v79, 0xffff0000, v11
    v_readfirstlane_b32 s20, v64
    v_readfirstlane_b32 s22, v72
    v_mov_b32 v116, 0x3b000000
    v_pk_add_f32 v[80:81], v[64:65], s[20:21] op_sel_hi:[1,0] neg_lo:[0,1] neg_hi:[0,1]
    v_pk_add_f32 v[88:89], v[72:73], s[22:23] op_sel_hi:[1,0] neg_lo:[0,1] neg_hi:[0,1]
    v_pk_add_f32 v[82:83], v[66:67], s[20:21] op_sel_hi:[1,0] neg_lo:[0,1] neg_hi:[0,1]
    v_pk_add_f32 v[90:91], v[74:75], s[22:23] op_sel_hi:[1,0] neg_lo:[0,1] neg_hi:[0,1]
    v_pk_add_f32 v[84:85], v[68:69], s[20:21] op_sel_hi:[1,0] neg_lo:[0,1] neg_hi:[0,1]
    v_pk_add_f32 v[92:93], v[76:77], s[22:23] op_sel_hi:[1,0] neg_lo:[0,1] neg_hi:[0,1]
    v_pk_add_f32 v[86:87], v[70:71], s[20:21] op_sel_hi:[1,0] neg_lo:[0,1] neg_hi:[0,1]
    v_pk_add_f32 v[94:95], v[78:79], s[22:23] op_sel_hi:[1,0] neg_lo:[0,1] neg_hi:[0,1]
    v_pk_add_f32 v[96:97], v[80:81], v[82:83]
    v_pk_mul_f32 v[104:105], v[80:81], v[80:81]
    v_pk_add_f32 v[98:99], v[84:85], v[86:87]
    v_pk_mul_f32 v[106:107], v[84:85], v[84:85]
    v_pk_add_f32 v[100:101], v[88:89], v[90:91]
    v_pk_mul_f32 v[108:109], v[88:89], v[88:89]
    v_pk_add_f32 v[102:103], v[92:93], v[94:95]
    v_pk_mul_f32 v[110:111], v[92:93], v[92:93]
    v_pk_fma_f32 v[104:105], v[82:83], v[82:83], v[104:105]
    v_pk_fma_f32 v[106:107], v[86:87], v[86:87], v[106:107]
    v_pk_add_f32 v[96:97], v[96:97], v[98:99]
    v_pk_fma_f32 v[108:109], v[90:91], v[90:91], v[108:109]
    v_pk_fma_f32 v[110:111], v[94:95], v[94:95], v[110:111]
    v_pk_add_f32 v[100:101], v[100:101], v[102:103]
    v_pk_add_f32 v[104:105], v[104:105], v[106:107]
    v_add_f32 v112, v96, v97
    v_pk_add_f32 v[108:109], v[108:109], v[110:111]
    v_add_f32 v113, v100, v101
    v_add_f32 v114, v104, v105
    v_add_f32 v115, v108, v109
    v_add_f32_dpp v112, v112, v112 quad_perm:[1,0,3,2] row_mask:0xf bank_mask:0xf
    v_add_f32_dpp v113, v113, v113 quad_perm:[1,0,3,2] row_mask:0xf bank_mask:0xf
    v_add_f32_dpp v114, v114, v114 quad_perm:[1,0,3,2] row_mask:0xf bank_mask:0xf
    v_add_f32_dpp v115, v115, v115 quad_perm:[1,0,3,2] row_mask:0xf bank_mask:0xf
    v_add_f32_dpp v112, v112, v112 quad_perm:[2,3,0,1] row_mask:0xf bank_mask:0xf
    v_add_f32_dpp v113, v113, v113 quad_perm:[2,3,0,1] row_mask:0xf bank_mask:0xf
    v_add_f32_dpp v114, v114, v114 quad_perm:[2,3,0,1] row_mask:0xf bank_mask:0xf
    v_add_f32_dpp v115, v115, v115 quad_perm:[2,3,0,1] row_mask:0xf bank_mask:0xf
    v_add_f32_dpp v112, v112, v112 row_half_mirror row_mask:0xf bank_mask:0xf
    v_add_f32_dpp v113, v113, v113 row_half_mirror row_mask:0xf bank_mask:0xf
    v_add_f32_dpp v114, v114, v114 row_half_mirror row_mask:0xf bank_mask:0xf
    v_add_f32_dpp v115, v115, v115 row_half_mirror row_mask:0xf bank_mask:0xf
    v_add_f32_dpp v112, v112, v112 row_mirror row_mask:0xf bank_mask:0xf
    v_add_f32_dpp v113, v113, v113 row_mirror row_mask:0xf bank_mask:0xf
    v_add_f32_dpp v114, v114, v114 row_mirror row_mask:0xf bank_mask:0xf
    v_add_f32_dpp v115, v115, v115 row_mirror row_mask:0xf bank_mask:0xf
    v_add_f32_dpp v112, v112, v112 row_bcast:15 row_mask:0xa bank_mask:0xf
    v_add_f32_dpp v113, v113, v113 row_bcast:15 row_mask:0xa bank_mask:0xf
    v_add_f32_dpp v114, v114, v114 row_bcast:15 row_mask:0xa bank_mask:0xf
    v_add_f32_dpp v115, v115, v115 row_bcast:15 row_mask:0xa bank_mask:0xf
    v_add_f32_dpp v112, v112, v112 row_bcast:31 row_mask:0xc bank_mask:0xf
    v_add_f32_dpp v113, v113, v113 row_bcast:31 row_mask:0xc bank_mask:0xf
    v_add_f32_dpp v114, v114, v114 row_bcast:31 row_mask:0xc bank_mask:0xf
    v_add_f32_dpp v115, v115, v115 row_bcast:31 row_mask:0xc bank_mask:0xf
    v_readlane_b32 s24, v112, 63
    v_readlane_b32 s25, v113, 63
    v_readlane_b32 s26, v114, 63
    v_readlane_b32 s27, v115, 63
    v_mul_f32 v80, s24, v116
    v_mul_f32 v82, s26, v116
    v_mul_f32 v81, s25, v116
    v_mul_f32 v83, s27, v116
    v_fma_f32 v82, -v80, v80, v82
    v_add_f32 v80, s20, v80
    v_fma_f32 v83, -v81, v81, v83
    v_add_f32 v81, s22, v81
    v_max_f32 v82, 0, v82
    v_max_f32 v83, 0, v83
    v_cvt_pk_bf16_f32 v94, v80, v81
    v_lshlrev_b32 v84, 16, v94
    v_and_b32 v85, 0xffff0000, v94
    v_cvt_pk_bf16_f32 v90, v82, v83
    v_lshlrev_b32 v82, 16, v90
    v_and_b32 v83, 0xffff0000, v90
    v_add_f32 v82, 0x3727c5ac, v82
    v_add_f32 v83, 0x3727c5ac, v83
    v_cvt_pk_bf16_f32 v90, v82, v83
    v_lshlrev_b32 v82, 16, v90
    v_and_b32 v83, 0xffff0000, v90
    v_sqrt_f32 v82, v82
    v_sqrt_f32 v83, v83
    s_nop 0
    v_cvt_pk_bf16_f32 v90, v82, v83
    v_lshlrev_b32 v82, 16, v90
    v_and_b32 v83, 0xffff0000, v90
    v_rcp_f32 v88, v82
    v_rcp_f32 v89, v83
    v_mul_f32_e64 v96, -v84, v88
    v_mul_f32_e64 v97, -v85, v89
    v_pk_fma_f32 v[64:65], v[64:65], v[88:89], v[96:97] op_sel:[0,0,0] op_sel_hi:[1,0,0]
    v_pk_fma_f32 v[72:73], v[72:73], v[88:89], v[96:97] op_sel:[0,1,1] op_sel_hi:[1,1,1]
    v_pk_fma_f32 v[66:67], v[66:67], v[88:89], v[96:97] op_sel:[0,0,0] op_sel_hi:[1,0,0]
    v_pk_fma_f32 v[74:75], v[74:75], v[88:89], v[96:97] op_sel:[0,1,1] op_sel_hi:[1,1,1]
    v_pk_fma_f32 v[68:69], v[68:69], v[88:89], v[96:97] op_sel:[0,0,0] op_sel_hi:[1,0,0]
    v_pk_fma_f32 v[76:77], v[76:77], v[88:89], v[96:97] op_sel:[0,1,1] op_sel_hi:[1,1,1]
    v_pk_fma_f32 v[70:71], v[70:71], v[88:89], v[96:97] op_sel:[0,0,0] op_sel_hi:[1,0,0]
    v_pk_fma_f32 v[78:79], v[78:79], v[88:89], v[96:97] op_sel:[0,1,1] op_sel_hi:[1,1,1]
    v_cvt_pk_bf16_f32 v4, v64, v65
    v_cvt_pk_bf16_f32 v8, v72, v73
    v_cvt_pk_bf16_f32 v5, v66, v67
    v_cvt_pk_bf16_f32 v9, v74, v75
    v_cvt_pk_bf16_f32 v6, v68, v69
    v_cvt_pk_bf16_f32 v10, v76, v77
    v_cvt_pk_bf16_f32 v7, v70, v71
    v_cvt_pk_bf16_f32 v11, v78, v79
    ds_write_b128 v58, v[4:7]
    ds_write_b128 v58, v[8:11] offset:1024
    ds_read_b64_tr_b16 v[60:61], v59
    ds_read_b64_tr_b16 v[62:63], v59 offset:512
    ds_read_b64_tr_b16 v[64:65], v59 offset:1024
    ds_read_b64_tr_b16 v[66:67], v59 offset:1536
    s_waitcnt lgkmcnt(2)
    v_mfma_f32_16x16x32_bf16 v[68:71], v[60:63], v[16:19], 0
    v_mfma_f32_16x16x32_bf16 v[72:75], v[60:63], v[20:23], 0
    v_mfma_f32_16x16x32_bf16 v[76:79], v[60:63], v[24:27], 0
    v_mfma_f32_16x16x32_bf16 v[80:83], v[60:63], v[28:31], 0
    s_waitcnt lgkmcnt(0)
    v_mfma_f32_16x16x32_bf16 v[84:87], v[64:67], v[16:19], 0
    v_mfma_f32_16x16x32_bf16 v[88:91], v[64:67], v[20:23], 0
    v_mfma_f32_16x16x32_bf16 v[92:95], v[64:67], v[24:27], 0
    v_mfma_f32_16x16x32_bf16 v[96:99], v[64:67], v[28:31], 0
    v_pk_mul_f32 v[116:117], v[68:69], v[32:33]
    v_pk_mul_f32 v[120:121], v[72:73], v[32:33]
    v_pk_mul_f32 v[118:119], v[70:71], v[34:35]
    v_pk_mul_f32 v[122:123], v[74:75], v[34:35]
    v_pk_fma_f32 v[116:117], v[72:73], v[40:41], v[116:117]
    v_pk_fma_f32 v[120:121], v[68:69], v[40:41], v[120:121] neg_lo:[1,0,0] neg_hi:[1,0,0]
    v_pk_fma_f32 v[118:119], v[74:75], v[42:43], v[118:119]
    v_pk_fma_f32 v[122:123], v[70:71], v[42:43], v[122:123] neg_lo:[1,0,0] neg_hi:[1,0,0]
    v_cvt_pk_bf16_f32 v100, v116, v120
    v_cvt_pk_bf16_f32 v101, v117, v121
    v_cvt_pk_bf16_f32 v102, v118, v122
    v_cvt_pk_bf16_f32 v103, v119, v123
    v_pk_mul_f32 v[116:117], v[76:77], v[36:37]
    v_pk_mul_f32 v[120:121], v[80:81], v[36:37]
    v_pk_mul_f32 v[118:119], v[78:79], v[38:39]
    v_pk_mul_f32 v[122:123], v[82:83], v[38:39]
    v_pk_fma_f32 v[116:117], v[80:81], v[44:45], v[116:117]
    v_pk_fma_f32 v[120:121], v[76:77], v[44:45], v[120:121] neg_lo:[1,0,0] neg_hi:[1,0,0]
    v_pk_fma_f32 v[118:119], v[82:83], v[46:47], v[118:119]
    v_pk_fma_f32 v[122:123], v[78:79], v[46:47], v[122:123] neg_lo:[1,0,0] neg_hi:[1,0,0]
    v_cvt_pk_bf16_f32 v104, v116, v120
    v_cvt_pk_bf16_f32 v105, v117, v121
    v_cvt_pk_bf16_f32 v106, v118, v122
    v_cvt_pk_bf16_f32 v107, v119, v123
    v_pk_mul_f32 v[116:117], v[84:85], v[32:33]
    v_pk_mul_f32 v[120:121], v[88:89], v[32:33]
    v_pk_mul_f32 v[118:119], v[86:87], v[34:35]
    v_pk_mul_f32 v[122:123], v[90:91], v[34:35]
    v_pk_fma_f32 v[116:117], v[88:89], v[40:41], v[116:117]
    v_pk_fma_f32 v[120:121], v[84:85], v[40:41], v[120:121] neg_lo:[1,0,0] neg_hi:[1,0,0]
    v_pk_fma_f32 v[118:119], v[90:91], v[42:43], v[118:119]
    v_pk_fma_f32 v[122:123], v[86:87], v[42:43], v[122:123] neg_lo:[1,0,0] neg_hi:[1,0,0]
    v_cvt_pk_bf16_f32 v108, v116, v120
    v_cvt_pk_bf16_f32 v109, v117, v121
    v_cvt_pk_bf16_f32 v110, v118, v122
    v_cvt_pk_bf16_f32 v111, v119, v123
    v_pk_mul_f32 v[116:117], v[92:93], v[36:37]
    v_pk_mul_f32 v[120:121], v[96:97], v[36:37]
    v_pk_mul_f32 v[118:119], v[94:95], v[38:39]
    v_pk_mul_f32 v[122:123], v[98:99], v[38:39]
    v_pk_fma_f32 v[116:117], v[96:97], v[44:45], v[116:117]
    v_pk_fma_f32 v[120:121], v[92:93], v[44:45], v[120:121] neg_lo:[1,0,0] neg_hi:[1,0,0]
    v_pk_fma_f32 v[118:119], v[98:99], v[46:47], v[118:119]
    v_pk_fma_f32 v[122:123], v[94:95], v[46:47], v[122:123] neg_lo:[1,0,0] neg_hi:[1,0,0]
    v_cvt_pk_bf16_f32 v112, v116, v120
    v_cvt_pk_bf16_f32 v113, v117, v121
    v_cvt_pk_bf16_f32 v114, v118, v122
    v_cvt_pk_bf16_f32 v115, v119, v123
    v_mfma_f32_16x16x32_bf16 v[68:71], v[48:51], v[100:103], 0
    v_mfma_f32_16x16x32_bf16 v[72:75], v[48:51], v[104:107], 0
    v_mfma_f32_16x16x32_bf16 v[76:79], v[48:51], v[108:111], 0
    v_mfma_f32_16x16x32_bf16 v[80:83], v[48:51], v[112:115], 0
    v_mfma_f32_16x16x32_bf16 v[84:87], v[52:55], v[100:103], 0
    v_mfma_f32_16x16x32_bf16 v[88:91], v[52:55], v[108:111], 0
    s_nop 6
    v_cndmask_b32_e64 v69, v69, v84, s[30:31]
    v_cndmask_b32_e64 v77, v77, v88, s[30:31]
    v_cvt_pk_bf16_f32 v4, v68, v69
    v_cvt_pk_bf16_f32 v5, v76, v77
    buffer_store_dwordx2 v[4:5], v56, s[16:19], s15 offen offset:0
    v_cvt_pk_bf16_f32 v6, v70, v71
    v_cvt_pk_bf16_f32 v7, v78, v79
    buffer_store_dwordx2 v[6:7], v56, s[16:19], s15 offen offset:1024
    v_cvt_pk_bf16_f32 v8, v72, v73
    v_cvt_pk_bf16_f32 v9, v80, v81
    buffer_store_dwordx2 v[8:9], v56, s[16:19], s15 offen offset:512
    v_cvt_pk_bf16_f32 v10, v74, v75
    v_cvt_pk_bf16_f32 v11, v82, v83
    buffer_store_dwordx2 v[10:11], v56, s[16:19], s15 offen offset:1536
    s_waitcnt vmcnt(4)
    v_lshl_or_b32 v64, v129, 16, v128
    v_lshl_or_b32 v65, v131, 16, v130
    v_lshl_or_b32 v66, v133, 16, v132
    v_lshl_or_b32 v67, v135, 16, v134
    v_lshl_or_b32 v68, v137, 16, v136
    v_lshl_or_b32 v69, v139, 16, v138
    v_lshl_or_b32 v70, v141, 16, v140
    v_lshl_or_b32 v71, v143, 16, v142
    ds_write_b128 v170, v[64:67]
    ds_write_b128 v170, v[68:71] offset:16
    v_lshlrev_b32 v72, 16, v144
    v_lshlrev_b32 v73, 16, v145
    v_lshlrev_b32 v74, 31, v1
    v_xor_b32 v73, v73, v74
    v_lshlrev_b32 v74, 30, v1
    v_and_b32 v74, 0x80000000, v74
    v_or_b32 v74, 0x3e800000, v74
    v_add_f32_dpp v72, v72, v72 quad_perm:[1,0,3,2] row_mask:0xf bank_mask:0xf
    v_add_f32_dpp v73, v73, v73 quad_perm:[1,0,3,2] row_mask:0xf bank_mask:0xf
    s_nop 0
    v_mov_b32_dpp v76, v72 quad_perm:[2,3,0,1] row_mask:0xf bank_mask:0xf
    v_mov_b32_dpp v77, v73 quad_perm:[2,3,0,1] row_mask:0xf bank_mask:0xf
    v_mul_f32 v76, 0.25, v76
    v_mul_f32 v77, 0.25, v77
    v_fmac_f32 v76, v72, v74
    v_fmac_f32 v77, v73, v74
    v_cvt_pk_bf16_f32 v72, v76, v77
    s_waitcnt lgkmcnt(0)
    s_barrier
    ds_read_b128 v[64:67], v171
    ds_read_b128 v[68:71], v171 offset:1152
    buffer_store_dword v72, v161, s[40:43], s29 offen
    s_waitcnt lgkmcnt(1)
    buffer_store_dwordx4 v[64:67], v159, s[40:43], s60 offen
    s_add_u32 s60, s60, 65536
    s_waitcnt lgkmcnt(0)
    buffer_store_dwordx4 v[68:71], v159, s[40:43], s60 offen
K1_END:
    s_endpgm

.globl k2_kernel
.p2align 8
.type k2_kernel,@function
k2_kernel:
    s_cmp_ge_u32 s2, 256
    s_cbranch_scc1 K2_END
    s_cmp_eq_u32 s2, 0
    s_cbranch_scc1 K2_SP
    s_load_dwordx2 s[4:5], s[0:1], 80
    s_load_dwordx2 s[44:45], s[0:1], 32
    v_and_b32 v1, 63, v0
    v_lshrrev_b32 v2, 6, v0
    s_and_b32 s12, s2, 7
    s_lshl_b32 s12, s12, 5
    v_readfirstlane_b32 s3, v2
    s_lshr_b32 s13, s2, 3
    s_add_u32 s12, s12, s13
    v_lshrrev_b32 v2, 4, v1
    v_and_b32 v3, 15, v1
    v_lshlrev_b32 v4, 3, v3
    v_lshrrev_b32 v5, 1, v2
    v_add_u32 v4, v4, v5
    v_mul_u32_u24 v4, 8320, v4
    v_and_b32 v5, 1, v2
    v_lshl_add_u32 v4, v5, 4, v4
    s_lshl_b32 s14, s3, 1
    s_mul_i32 s14, s14, 8320
    s_lshl_b32 s15, s12, 5
    s_add_u32 s14, s14, s15
    s_add_u32 s15, s14, 1064960
    s_lshl_b32 s16, s3, 11
    v_lshlrev_b32 v5, 4, v1
    s_lshl_b32 s17, s12, 13
    s_add_u32 s17, s17, s16
    v_cvt_f32_u32 v176, v1
    v_mul_f32 v176, 0x3c800000, v176
    v_cos_f32 v177, v176
    v_sin_f32 v178, v176
    s_lshl_b32 s18, s3, 9
    s_add_u32 s18, s18, 16384
    v_mov_b32 v6, s18
    v_cvt_pk_bf16_f32 v177, v177, v178
    v_lshl_add_u32 v178, v1, 2, v6
    ds_write2st64_b32 v178, v177, v177 offset0:0 offset1:1
    s_mov_b32 s19, 0xff
    s_lshl_b32 s28, s3, 4
    v_add_u32 v7, s28, v3
    v_lshlrev_b32 v8, 2, v7
    v_lshlrev_b32 v9, 2, v2
    v_mul_u32_u24 v10, v9, v8
    v_mad_u32_u24 v180, v8, 0, v10
    v_and_or_b32 v180, v180, s19, v6
    v_mad_u32_u24 v181, v8, 1, v10
    v_and_or_b32 v181, v181, s19, v6
    v_mad_u32_u24 v182, v8, 2, v10
    v_and_or_b32 v182, v182, s19, v6
    v_mad_u32_u24 v183, v8, 3, v10
    v_and_or_b32 v183, v183, s19, v6
    v_mad_u32_u24 v184, v8, 16, v10
    v_and_or_b32 v184, v184, s19, v6
    v_mad_u32_u24 v185, v8, 17, v10
    v_and_or_b32 v185, v185, s19, v6
    v_mad_u32_u24 v186, v8, 18, v10
    v_and_or_b32 v186, v186, s19, v6
    v_mad_u32_u24 v187, v8, 19, v10
    v_and_or_b32 v187, v187, s19, v6
    v_lshlrev_b32 v11, 3, v3
    v_mul_u32_u24 v12, v9, v11
    v_mad_u32_u24 v188, v11, 0, v12
    v_and_or_b32 v188, v188, s19, v6
    v_mad_u32_u24 v189, v11, 1, v12
    v_and_or_b32 v189, v189, s19, v6
    v_mad_u32_u24 v190, v11, 2, v12
    v_and_or_b32 v190, v190, s19, v6
    v_mad_u32_u24 v191, v11, 3, v12
    v_and_or_b32 v191, v191, s19, v6
    ds_read_b32 v16, v180
    ds_read_b32 v20, v180 offset:64
    ds_read_b32 v17, v181
    ds_read_b32 v21, v181 offset:64
    ds_read_b32 v18, v182
    ds_read_b32 v22, v182 offset:64
    ds_read_b32 v19, v183
    ds_read_b32 v23, v183 offset:64
    ds_read_b32 v24, v184
    ds_read_b32 v28, v184 offset:64
    ds_read_b32 v25, v185
    ds_read_b32 v29, v185 offset:64
    ds_read_b32 v26, v186
    ds_read_b32 v30, v186 offset:64
    ds_read_b32 v27, v187
    ds_read_b32 v31, v187 offset:64
    ds_read_b32 v48, v188
    ds_read_b32 v52, v188 offset:64
    ds_read_b32 v49, v189
    ds_read_b32 v53, v189 offset:64
    ds_read_b32 v50, v190
    ds_read_b32 v54, v190 offset:64
    ds_read_b32 v51, v191
    ds_read_b32 v55, v191 offset:64
    s_waitcnt lgkmcnt(0)
    s_mov_b32 s8, s4
    s_and_b32 s9, s5, 0xffff
    s_mov_b32 s10, 0x208000
    s_mov_b32 s11, 0x20000
    s_mov_b32 m0, s16
    s_add_u32 s20, s4, 0x300000
    s_addc_u32 s21, s5, 0
    s_and_b32 s21, s21, 0xffff
    s_mov_b32 s22, 0x204000
    s_mov_b32 s23, 0x20000
    buffer_load_dwordx4 v4, s[8:11], s14 offen lds
    s_add_u32 m0, s16, 1024
    s_add_u32 s24, s4, 0x600000
    s_addc_u32 s25, s5, 0
    s_and_b32 s25, s25, 0xffff
    s_mov_b32 s26, 0x20a080
    s_mov_b32 s27, 0x20000
    buffer_load_dwordx4 v4, s[8:11], s15 offen lds
    s_lshr_b32 s56, s2, 3
    s_lshl_b32 s56, s56, 2
    s_add_u32 s56, s56, s3
    s_sub_u32 s56, 127, s56
    s_and_b32 s57, s2, 7
    s_mul_i32 s57, s57, 116
    s_add_u32 s57, s57, s56
    s_lshr_b32 s58, s57, 5
    s_bfe_u32 s59, s57, 0x40001
    s_and_b32 s57, s57, 1
    s_lshl_b32 s63, s58, 6
    s_lshl_b32 s62, s59, 1
    s_add_u32 s63, s63, s62
    s_add_u32 s63, s63, s57
    s_add_u32 s63, s63, 0
    s_mul_i32 s63, s63, 3072
    s_lshl_b32 s57, s57, 10
    s_add_u32 s57, s57, s59
    s_add_u32 s57, s57, 0
    s_mul_i32 s62, s57, 2752
    s_mul_i32 s58, s58, 96
    s_add_u32 s62, s62, s58
    s_cmp_ge_u32 s56, 116
    s_cselect_b32 s62, 0x7000000, s62
    s_cselect_b32 s63, 0x7000000, s63
    v_add_u32 v212, 0, v1
    v_mul_u32_u24 v213, 171, v212
    v_lshrrev_b32 v213, 10, v213
    v_mul_u32_u24 v214, 6, v213
    v_sub_u32 v212, v212, v214
    v_bfe_u32 v214, v213, 2, 2
    v_lshlrev_b32 v214, 8, v214
    v_lshrrev_b32 v208, 4, v213
    v_lshl_add_u32 v214, v208, 7, v214
    v_and_b32 v213, 3, v213
    v_lshl_add_u32 v214, v213, 5, v214
    v_mul_u32_u24 v214, 2752, v214
    v_lshl_add_u32 v208, v212, 4, v214
    v_add_u32 v212, 64, v1
    v_mul_u32_u24 v213, 171, v212
    v_lshrrev_b32 v213, 10, v213
    v_mul_u32_u24 v214, 6, v213
    v_sub_u32 v212, v212, v214
    v_bfe_u32 v214, v213, 2, 2
    v_lshlrev_b32 v214, 8, v214
    v_lshrrev_b32 v209, 4, v213
    v_lshl_add_u32 v214, v209, 7, v214
    v_and_b32 v213, 3, v213
    v_lshl_add_u32 v214, v213, 5, v214
    v_mul_u32_u24 v214, 2752, v214
    v_lshl_add_u32 v209, v212, 4, v214
    v_add_u32 v212, 128, v1
    v_mul_u32_u24 v213, 171, v212
    v_lshrrev_b32 v213, 10, v213
    v_mul_u32_u24 v214, 6, v213
    v_sub_u32 v212, v212, v214
    v_bfe_u32 v214, v213, 2, 2
    v_lshlrev_b32 v214, 8, v214
    v_lshrrev_b32 v210, 4, v213
    v_lshl_add_u32 v214, v210, 7, v214
    v_and_b32 v213, 3, v213
    v_lshl_add_u32 v214, v213, 5, v214
    v_mul_u32_u24 v214, 2752, v214
    v_lshl_add_u32 v210, v212, 4, v214
    v_lshlrev_b32 v211, 4, v1
    s_mov_b32 s40, s44
    s_and_b32 s41, s45, 0xffff
    s_mov_b32 s42, 0x560000
    s_mov_b32 s43, 0x20000
    s_add_u32 s36, s4, 0x1100000
    s_addc_u32 s37, s5, 0
    s_and_b32 s37, s37, 0xffff
    s_mov_b32 s38, 0x570000
    s_mov_b32 s39, 0x20000
    v_cvt_f32_u32 v176, v7
    v_mul_f32 v176, 0x3a000000, v176
    v_cvt_f32_u32 v177, v9
    v_add_f32 v178, 0x00000000, v177
    v_mul_f32 v178, v178, v176
    v_cos_f32 v80, v178
    v_sin_f32 v88, v178
    v_add_f32 v178, 0x3f800000, v177
    v_mul_f32 v178, v178, v176
    v_cos_f32 v81, v178
    v_sin_f32 v89, v178
    v_add_f32 v178, 0x40000000, v177
    v_mul_f32 v178, v178, v176
    v_cos_f32 v82, v178
    v_sin_f32 v90, v178
    v_add_f32 v178, 0x40400000, v177
    v_mul_f32 v178, v178, v176
    v_cos_f32 v83, v178
    v_sin_f32 v91, v178
    v_add_f32 v178, 0x41800000, v177
    v_mul_f32 v178, v178, v176
    v_cos_f32 v84, v178
    v_sin_f32 v92, v178
    v_add_f32 v178, 0x41880000, v177
    v_mul_f32 v178, v178, v176
    v_cos_f32 v85, v178
    v_sin_f32 v93, v178
    v_add_f32 v178, 0x41900000, v177
    v_mul_f32 v178, v178, v176
    v_cos_f32 v86, v178
    v_sin_f32 v94, v178
    v_add_f32 v178, 0x41980000, v177
    v_mul_f32 v178, v178, v176
    v_cos_f32 v87, v178
    v_sin_f32 v95, v178
    buffer_load_dwordx4 v[112:115], v5, s[20:23], s17 offen
    buffer_load_dwordx4 v[116:119], v5, s[20:23], s17 offen offset:1024
    v_add_u32 v13, s28, v9
    v_cvt_f32_u32 v177, v13
    v_cvt_f32_u32 v176, v3
    v_mul_f32 v176, 0x3a000000, v176
    v_add_f32 v179, 0x3c000000, v176
    v_add_f32 v178, 0x00000000, v177
    v_mul_f32 v178, v178, v176
    v_cos_f32 v96, v178
    v_sin_f32 v104, v178
    v_add_f32 v178, 0x3f800000, v177
    v_mul_f32 v178, v178, v176
    v_cos_f32 v97, v178
    v_sin_f32 v105, v178
    v_add_f32 v178, 0x40000000, v177
    v_mul_f32 v178, v178, v176
    v_cos_f32 v98, v178
    v_sin_f32 v106, v178
    v_add_f32 v178, 0x40400000, v177
    v_mul_f32 v178, v178, v176
    v_cos_f32 v99, v178
    v_sin_f32 v107, v178
    v_add_f32 v178, 0x00000000, v177
    v_mul_f32 v178, v178, v179
    v_cos_f32 v100, v178
    v_sin_f32 v108, v178
    v_add_f32 v178, 0x3f800000, v177
    v_mul_f32 v178, v178, v179
    v_cos_f32 v101, v178
    v_sin_f32 v109, v178
    v_add_f32 v178, 0x40000000, v177
    v_mul_f32 v178, v178, v179
    v_cos_f32 v102, v178
    v_sin_f32 v110, v178
    v_add_f32 v178, 0x40400000, v177
    v_mul_f32 v178, v178, v179
    v_cos_f32 v103, v178
    v_sin_f32 v111, v178
    v_and_b32 v14, 1, v1
    v_mul_u32_u24 v14, 0x8000, v14
    v_lshl_or_b32 v14, v14, 16, v14
    s_waitcnt lgkmcnt(0)
    v_xor_b32 v32, v16, v14
    v_xor_b32 v33, v17, v14
    v_xor_b32 v34, v18, v14
    v_xor_b32 v35, v19, v14
    v_xor_b32 v36, v20, v14
    v_xor_b32 v37, v21, v14
    v_xor_b32 v38, v22, v14
    v_xor_b32 v39, v23, v14
    v_xor_b32 v40, v24, v14
    v_xor_b32 v41, v25, v14
    v_xor_b32 v42, v26, v14
    v_xor_b32 v43, v27, v14
    v_xor_b32 v44, v28, v14
    v_xor_b32 v45, v29, v14
    v_xor_b32 v46, v30, v14
    v_xor_b32 v47, v31, v14
    v_xor_b32 v56, v48, v14
    v_xor_b32 v57, v49, v14
    v_xor_b32 v58, v50, v14
    v_xor_b32 v59, v51, v14
    v_xor_b32 v60, v52, v14
    v_xor_b32 v61, v53, v14
    v_xor_b32 v62, v54, v14
    v_xor_b32 v63, v55, v14
    v_mov_b32 v64, v48
    v_xor_b32 v65, 0x80008000, v49
    v_mov_b32 v66, v50
    v_xor_b32 v67, 0x80008000, v51
    v_mov_b32 v68, v52
    v_xor_b32 v69, 0x80008000, v53
    v_mov_b32 v70, v54
    v_xor_b32 v71, 0x80008000, v55
    v_mov_b32 v72, v56
    v_xor_b32 v73, 0x80008000, v57
    v_mov_b32 v74, v58
    v_xor_b32 v75, 0x80008000, v59
    v_mov_b32 v76, v60
    v_xor_b32 v77, 0x80008000, v61
    v_mov_b32 v78, v62
    v_xor_b32 v79, 0x80008000, v63
    v_lshlrev_b32 v15, 8, v3
    v_lshl_add_u32 v15, v2, 4, v15
    s_mul_i32 s29, s12, 8320
    s_lshl_b32 s30, s3, 6
    s_add_u32 s29, s29, s30
    s_add_u32 s30, s29, 4096
    s_waitcnt vmcnt(2)
    buffer_load_dwordx4 v[196:199], v208, s[40:43], s62 offen
    buffer_load_dwordx4 v[200:203], v209, s[40:43], s62 offen
    buffer_load_dwordx4 v[204:207], v210, s[40:43], s62 offen
    s_barrier
    ds_read_b128 v[120:123], v5 offset:0
    ds_read_b128 v[124:127], v5 offset:1024
    ds_read_b128 v[128:131], v5 offset:2048
    ds_read_b128 v[132:135], v5 offset:3072
    ds_read_b128 v[136:139], v5 offset:4096
    ds_read_b128 v[140:143], v5 offset:5120
    ds_read_b128 v[144:147], v5 offset:6144
    ds_read_b128 v[148:151], v5 offset:7168
    s_waitcnt lgkmcnt(6)
    v_mfma_f32_16x16x32_bf16 v[152:155], v[120:123], v[16:19], 0
    v_mfma_f32_16x16x32_bf16 v[156:159], v[120:123], v[20:23], 0
    v_mfma_f32_16x16x32_bf16 v[160:163], v[124:127], v[16:19], 0
    v_mfma_f32_16x16x32_bf16 v[164:167], v[124:127], v[20:23], 0
    s_waitcnt lgkmcnt(4)
    v_mfma_f32_16x16x32_bf16 v[152:155], v[128:131], v[24:27], v[152:155]
    v_mfma_f32_16x16x32_bf16 v[156:159], v[128:131], v[28:31], v[156:159]
    v_mfma_f32_16x16x32_bf16 v[160:163], v[132:135], v[24:27], v[160:163]
    v_mfma_f32_16x16x32_bf16 v[164:167], v[132:135], v[28:31], v[164:167]
    s_waitcnt lgkmcnt(2)
    v_mfma_f32_16x16x32_bf16 v[152:155], v[136:139], v[32:35], v[152:155]
    v_mfma_f32_16x16x32_bf16 v[156:159], v[136:139], v[36:39], v[156:159]
    v_mfma_f32_16x16x32_bf16 v[160:163], v[140:143], v[32:35], v[160:163]
    v_mfma_f32_16x16x32_bf16 v[164:167], v[140:143], v[36:39], v[164:167]
    s_waitcnt lgkmcnt(0)
    v_mfma_f32_16x16x32_bf16 v[152:155], v[144:147], v[40:43], v[152:155]
    v_mfma_f32_16x16x32_bf16 v[156:159], v[144:147], v[44:47], v[156:159]
    v_mfma_f32_16x16x32_bf16 v[160:163], v[148:151], v[40:43], v[160:163]
    v_mfma_f32_16x16x32_bf16 v[164:167], v[148:151], v[44:47], v[164:167]
    s_nop 4
    v_pk_mul_f32 v[176:177], v[152:153], v[80:81]
    v_pk_mul_f32 v[180:181], v[156:157], v[80:81]
    v_pk_mul_f32 v[178:179], v[154:155], v[82:83]
    v_pk_mul_f32 v[182:183], v[158:159], v[82:83]
    v_pk_fma_f32 v[176:177], v[156:157], v[88:89], v[176:177]
    v_pk_fma_f32 v[180:181], v[152:153], v[88:89], v[180:181] neg_lo:[1,0,0] neg_hi:[1,0,0]
    v_pk_fma_f32 v[178:179], v[158:159], v[90:91], v[178:179]
    v_pk_fma_f32 v[182:183], v[154:155], v[90:91], v[182:183] neg_lo:[1,0,0] neg_hi:[1,0,0]
    v_cvt_pk_bf16_f32 v168, v176, v180
    v_cvt_pk_bf16_f32 v169, v177, v181
    v_cvt_pk_bf16_f32 v170, v178, v182
    v_cvt_pk_bf16_f32 v171, v179, v183
    v_pk_mul_f32 v[176:177], v[160:161], v[84:85]
    v_pk_mul_f32 v[180:181], v[164:165], v[84:85]
    v_pk_mul_f32 v[178:179], v[162:163], v[86:87]
    v_pk_mul_f32 v[182:183], v[166:167], v[86:87]
    v_pk_fma_f32 v[176:177], v[164:165], v[92:93], v[176:177]
    v_pk_fma_f32 v[180:181], v[160:161], v[92:93], v[180:181] neg_lo:[1,0,0] neg_hi:[1,0,0]
    v_pk_fma_f32 v[178:179], v[166:167], v[94:95], v[178:179]
    v_pk_fma_f32 v[182:183], v[162:163], v[94:95], v[182:183] neg_lo:[1,0,0] neg_hi:[1,0,0]
    v_cvt_pk_bf16_f32 v172, v176, v180
    v_cvt_pk_bf16_f32 v173, v177, v181
    v_cvt_pk_bf16_f32 v174, v178, v182
    v_cvt_pk_bf16_f32 v175, v179, v183
    v_mfma_f32_16x16x32_bf16 v[152:155], v[48:51], v[168:171], 0
    v_mfma_f32_16x16x32_bf16 v[156:159], v[52:55], v[168:171], 0
    v_mfma_f32_16x16x32_bf16 v[160:163], v[64:67], v[168:171], 0
    v_mfma_f32_16x16x32_bf16 v[164:167], v[68:71], v[168:171], 0
    v_mfma_f32_16x16x32_bf16 v[152:155], v[56:59], v[172:175], v[152:155]
    v_mfma_f32_16x16x32_bf16 v[156:159], v[60:63], v[172:175], v[156:159]
    v_mfma_f32_16x16x32_bf16 v[160:163], v[72:75], v[172:175], v[160:163]
    v_mfma_f32_16x16x32_bf16 v[164:167], v[76:79], v[172:175], v[164:167]
    s_waitcnt vmcnt(3)
    v_lshlrev_b32 v224, 16, v112
    v_and_b32 v232, 0xffff0000, v112
    v_lshlrev_b32 v225, 16, v113
    v_and_b32 v233, 0xffff0000, v113
    v_lshlrev_b32 v226, 16, v114
    v_and_b32 v234, 0xffff0000, v114
    v_lshlrev_b32 v227, 16, v115
    v_and_b32 v235, 0xffff0000, v115
    v_lshlrev_b32 v228, 16, v116
    v_and_b32 v236, 0xffff0000, v116
    v_lshlrev_b32 v229, 16, v117
    v_and_b32 v237, 0xffff0000, v117
    v_lshlrev_b32 v230, 16, v118
    v_and_b32 v238, 0xffff0000, v118
    v_lshlrev_b32 v231, 16, v119
    v_and_b32 v239, 0xffff0000, v119
    v_pk_mul_f32 v[176:177], v[152:153], v[224:225]
    v_pk_mul_f32 v[180:181], v[156:157], v[224:225]
    v_pk_mul_f32 v[178:179], v[154:155], v[226:227]
    v_pk_mul_f32 v[182:183], v[158:159], v[226:227]
    v_pk_fma_f32 v[176:177], v[156:157], v[232:233], v[176:177] neg_lo:[1,0,0] neg_hi:[1,0,0]
    v_pk_fma_f32 v[180:181], v[152:153], v[232:233], v[180:181]
    v_pk_fma_f32 v[178:179], v[158:159], v[234:235], v[178:179] neg_lo:[1,0,0] neg_hi:[1,0,0]
    v_pk_fma_f32 v[182:183], v[154:155], v[234:235], v[182:183]
    v_cvt_pk_bf16_f32 v168, v176, -v180
    v_cvt_pk_bf16_f32 v169, v177, -v181
    v_cvt_pk_bf16_f32 v170, v178, -v182
    v_cvt_pk_bf16_f32 v171, v179, -v183
    v_pk_mul_f32 v[176:177], v[160:161], v[228:229]
    v_pk_mul_f32 v[180:181], v[164:165], v[228:229]
    v_pk_mul_f32 v[178:179], v[162:163], v[230:231]
    v_pk_mul_f32 v[182:183], v[166:167], v[230:231]
    v_pk_fma_f32 v[176:177], v[164:165], v[236:237], v[176:177] neg_lo:[1,0,0] neg_hi:[1,0,0]
    v_pk_fma_f32 v[180:181], v[160:161], v[236:237], v[180:181]
    v_pk_fma_f32 v[178:179], v[166:167], v[238:239], v[178:179] neg_lo:[1,0,0] neg_hi:[1,0,0]
    v_pk_fma_f32 v[182:183], v[162:163], v[238:239], v[182:183]
    v_cvt_pk_bf16_f32 v172, v176, -v180
    v_cvt_pk_bf16_f32 v173, v177, -v181
    v_cvt_pk_bf16_f32 v174, v178, -v182
    v_cvt_pk_bf16_f32 v175, v179, -v183
    v_mfma_f32_16x16x32_bf16 v[152:155], v[168:171], v[48:51], 0
    v_mfma_f32_16x16x32_bf16 v[156:159], v[168:171], v[52:55], 0
    v_mfma_f32_16x16x32_bf16 v[160:163], v[168:171], v[64:67], 0
    v_mfma_f32_16x16x32_bf16 v[164:167], v[168:171], v[68:71], 0
    v_mfma_f32_16x16x32_bf16 v[152:155], v[172:175], v[56:59], v[152:155]
    v_mfma_f32_16x16x32_bf16 v[156:159], v[172:175], v[60:63], v[156:159]
    v_mfma_f32_16x16x32_bf16 v[160:163], v[172:175], v[72:75], v[160:163]
    v_mfma_f32_16x16x32_bf16 v[164:167], v[172:175], v[76:79], v[164:167]
    s_nop 4
    v_pk_mul_f32 v[176:177], v[152:153], v[96:97]
    v_pk_mul_f32 v[180:181], v[156:157], v[96:97]
    v_pk_mul_f32 v[178:179], v[154:155], v[98:99]
    v_pk_mul_f32 v[182:183], v[158:159], v[98:99]
    v_pk_fma_f32 v[176:177], v[156:157], v[104:105], v[176:177]
    v_pk_fma_f32 v[180:181], v[152:153], v[104:105], v[180:181] neg_lo:[1,0,0] neg_hi:[1,0,0]
    v_pk_fma_f32 v[178:179], v[158:159], v[106:107], v[178:179]
    v_pk_fma_f32 v[182:183], v[154:155], v[106:107], v[182:183] neg_lo:[1,0,0] neg_hi:[1,0,0]
    v_cvt_pk_bf16_f32 v168, v176, v180
    v_cvt_pk_bf16_f32 v169, v177, v181
    v_cvt_pk_bf16_f32 v170, v178, v182
    v_cvt_pk_bf16_f32 v171, v179, v183
    v_pk_mul_f32 v[176:177], v[160:161], v[100:101]
    v_pk_mul_f32 v[180:181], v[164:165], v[100:101]
    v_pk_mul_f32 v[178:179], v[162:163], v[102:103]
    v_pk_mul_f32 v[182:183], v[166:167], v[102:103]
    v_pk_fma_f32 v[176:177], v[164:165], v[108:109], v[176:177]
    v_pk_fma_f32 v[180:181], v[160:161], v[108:109], v[180:181] neg_lo:[1,0,0] neg_hi:[1,0,0]
    v_pk_fma_f32 v[178:179], v[166:167], v[110:111], v[178:179]
    v_pk_fma_f32 v[182:183], v[162:163], v[110:111], v[182:183] neg_lo:[1,0,0] neg_hi:[1,0,0]
    v_cvt_pk_bf16_f32 v172, v176, v180
    v_cvt_pk_bf16_f32 v173, v177, v181
    v_cvt_pk_bf16_f32 v174, v178, v182
    v_cvt_pk_bf16_f32 v175, v179, v183
    s_add_u32 s31, s16, 8192
    v_add_u32 v4, s31, v5
    ds_write_b128 v4, v[168:171]
    ds_write_b128 v4, v[172:175] offset:1024
    s_waitcnt lgkmcnt(0)
    s_barrier
    ds_read_b128 v[120:123], v5 offset:8192
    ds_read_b128 v[124:127], v5 offset:9216
    ds_read_b128 v[128:131], v5 offset:10240
    ds_read_b128 v[132:135], v5 offset:11264
    ds_read_b128 v[136:139], v5 offset:12288
    ds_read_b128 v[140:143], v5 offset:13312
    ds_read_b128 v[144:147], v5 offset:14336
    ds_read_b128 v[148:151], v5 offset:15360
    s_waitcnt lgkmcnt(6)
    v_mfma_f32_16x16x32_bf16 v[152:155], v[16:19], v[120:123], 0
    v_mfma_f32_16x16x32_bf16 v[156:159], v[20:23], v[120:123], 0
    v_mfma_f32_16x16x32_bf16 v[160:163], v[16:19], v[124:127], 0
    v_mfma_f32_16x16x32_bf16 v[164:167], v[20:23], v[124:127], 0
    s_waitcnt lgkmcnt(4)
    v_mfma_f32_16x16x32_bf16 v[152:155], v[24:27], v[128:131], v[152:155]
    v_mfma_f32_16x16x32_bf16 v[156:159], v[28:31], v[128:131], v[156:159]
    v_mfma_f32_16x16x32_bf16 v[160:163], v[24:27], v[132:135], v[160:163]
    v_mfma_f32_16x16x32_bf16 v[164:167], v[28:31], v[132:135], v[164:167]
    s_waitcnt lgkmcnt(2)
    v_mfma_f32_16x16x32_bf16 v[152:155], v[32:35], v[136:139], v[152:155]
    v_mfma_f32_16x16x32_bf16 v[156:159], v[36:39], v[136:139], v[156:159]
    v_mfma_f32_16x16x32_bf16 v[160:163], v[32:35], v[140:143], v[160:163]
    v_mfma_f32_16x16x32_bf16 v[164:167], v[36:39], v[140:143], v[164:167]
    s_waitcnt lgkmcnt(0)
    v_mfma_f32_16x16x32_bf16 v[152:155], v[40:43], v[144:147], v[152:155]
    v_mfma_f32_16x16x32_bf16 v[156:159], v[44:47], v[144:147], v[156:159]
    v_mfma_f32_16x16x32_bf16 v[160:163], v[40:43], v[148:151], v[160:163]
    v_mfma_f32_16x16x32_bf16 v[164:167], v[44:47], v[148:151], v[164:167]
    s_nop 5
    v_cvt_pk_bf16_f32 v168, v152, -v156
    v_cvt_pk_bf16_f32 v169, v153, -v157
    v_cvt_pk_bf16_f32 v170, v154, -v158
    v_cvt_pk_bf16_f32 v171, v155, -v159
    buffer_store_dwordx4 v[168:171], v15, s[24:27], s29 offen
    v_cvt_pk_bf16_f32 v172, v160, -v164
    v_cvt_pk_bf16_f32 v173, v161, -v165
    v_cvt_pk_bf16_f32 v174, v162, -v166
    v_cvt_pk_bf16_f32 v175, v163, -v167
    buffer_store_dwordx4 v[172:175], v15, s[24:27], s30 offen
    s_waitcnt vmcnt(2)
    buffer_store_dwordx4 v[196:199], v211, s[36:39], s63 offen offset:0
    buffer_store_dwordx4 v[200:203], v211, s[36:39], s63 offen offset:1024
    buffer_store_dwordx4 v[204:207], v211, s[36:39], s63 offen offset:2048
K2_END:
    s_endpgm
K2_SP:
    s_load_dwordx2 s[4:5], s[0:1], 80
    v_and_b32 v1, 63, v0
    v_lshrrev_b32 v2, 6, v0
    s_and_b32 s12, s2, 7
    s_lshl_b32 s12, s12, 5
    v_readfirstlane_b32 s3, v2
    s_lshr_b32 s13, s2, 3
    s_add_u32 s12, s12, s13
    v_lshrrev_b32 v2, 4, v1
    v_and_b32 v3, 15, v1
    v_lshlrev_b32 v4, 3, v3
    v_lshrrev_b32 v5, 1, v2
    v_add_u32 v4, v4, v5
    v_mul_u32_u24 v4, 8320, v4
    v_and_b32 v5, 1, v2
    v_lshl_add_u32 v4, v5, 4, v4
    s_lshl_b32 s14, s3, 1
    s_mul_i32 s14, s14, 8320
    s_lshl_b32 s15, s12, 5
    s_add_u32 s14, s14, s15
    s_add_u32 s15, s14, 1064960
    s_lshl_b32 s16, s3, 11
    v_lshlrev_b32 v5, 4, v1
    s_lshl_b32 s17, s12, 13
    s_add_u32 s17, s17, s16
    v_cvt_f32_u32 v176, v1
    v_mul_f32 v176, 0x3c800000, v176
    v_cos_f32 v177, v176
    v_sin_f32 v178, v176
    s_lshl_b32 s18, s3, 9
    s_add_u32 s18, s18, 16384
    v_mov_b32 v6, s18
    v_cvt_pk_bf16_f32 v177, v177, v178
    v_lshl_add_u32 v178, v1, 2, v6
    ds_write2st64_b32 v178, v177, v177 offset0:0 offset1:1
    s_mov_b32 s19, 0xff
    s_lshl_b32 s28, s3, 4
    v_add_u32 v7, s28, v3
    v_lshlrev_b32 v8, 2, v7
    v_lshlrev_b32 v9, 2, v2
    v_mul_u32_u24 v10, v9, v8
    v_mad_u32_u24 v180, v8, 0, v10
    v_and_or_b32 v180, v180, s19, v6
    v_mad_u32_u24 v181, v8, 1, v10
    v_and_or_b32 v181, v181, s19, v6
    v_mad_u32_u24 v182, v8, 2, v10
    v_and_or_b32 v182, v182, s19, v6
    v_mad_u32_u24 v183, v8, 3, v10
    v_and_or_b32 v183, v183, s19, v6
    v_mad_u32_u24 v184, v8, 16, v10
    v_and_or_b32 v184, v184, s19, v6
    v_mad_u32_u24 v185, v8, 17, v10
    v_and_or_b32 v185, v185, s19, v6
    v_mad_u32_u24 v186, v8, 18, v10
    v_and_or_b32 v186, v186, s19, v6
    v_mad_u32_u24 v187, v8, 19, v10
    v_and_or_b32 v187, v187, s19, v6
    v_lshlrev_b32 v11, 3, v3
    v_mul_u32_u24 v12, v9, v11
    v_mad_u32_u24 v188, v11, 0, v12
    v_and_or_b32 v188, v188, s19, v6
    v_mad_u32_u24 v189, v11, 1, v12
    v_and_or_b32 v189, v189, s19, v6
    v_mad_u32_u24 v190, v11, 2, v12
    v_and_or_b32 v190, v190, s19, v6
    v_mad_u32_u24 v191, v11, 3, v12
    v_and_or_b32 v191, v191, s19, v6
    ds_read_b32 v16, v180
    ds_read_b32 v20, v180 offset:64
    ds_read_b32 v17, v181
    ds_read_b32 v21, v181 offset:64
    ds_read_b32 v18, v182
    ds_read_b32 v22, v182 offset:64
    ds_read_b32 v19, v183
    ds_read_b32 v23, v183 offset:64
    ds_read_b32 v24, v184
    ds_read_b32 v28, v184 offset:64
    ds_read_b32 v25, v185
    ds_read_b32 v29, v185 offset:64
    ds_read_b32 v26, v186
    ds_read_b32 v30, v186 offset:64
    ds_read_b32 v27, v187
    ds_read_b32 v31, v187 offset:64
    ds_read_b32 v48, v188
    ds_read_b32 v52, v188 offset:64
    ds_read_b32 v49, v189
    ds_read_b32 v53, v189 offset:64
    ds_read_b32 v50, v190
    ds_read_b32 v54, v190 offset:64
    ds_read_b32 v51, v191
    ds_read_b32 v55, v191 offset:64
    s_waitcnt lgkmcnt(0)
    s_mov_b32 s8, s4
    s_and_b32 s9, s5, 0xffff
    s_mov_b32 s10, 0x208000
    s_mov_b32 s11, 0x20000
    s_mov_b32 m0, s16
    s_add_u32 s20, s4, 0x300000
    s_addc_u32 s21, s5, 0
    s_and_b32 s21, s21, 0xffff
    s_mov_b32 s22, 0x204000
    s_mov_b32 s23, 0x20000
    buffer_load_dwordx4 v4, s[8:11], s14 offen lds
    s_add_u32 m0, s16, 1024
    s_add_u32 s24, s4, 0x600000
    s_addc_u32 s25, s5, 0
    s_and_b32 s25, s25, 0xffff
    s_mov_b32 s26, 0x20a080
    s_mov_b32 s27, 0x20000
    buffer_load_dwordx4 v4, s[8:11], s15 offen lds
    v_sub_u32 v120, 64, v7
    v_cmp_eq_u32 vcc, 0, v7
    v_sub_u32 v122, 12, v9
    s_nop 0
    v_addc_co_u32 v122, vcc, 0, v122, vcc
    v_lshlrev_b32 v121, 2, v9
    v_sub_u32 v120, v120, v121
    v_subrev_u32 v121, 16, v120
    v_and_b32 v121, 63, v121
    v_lshlrev_b32 v121, 2, v121
    v_lshl_add_u32 v213, v122, 8, v121
    v_add_u32 v213, 18432, v213
    v_cmp_eq_u32 vcc, 0, v7
    v_mov_b32 v121, 16
    s_nop 0
    v_cndmask_b32_e64 v121, v121, 0, vcc
    v_sub_u32 v121, v120, v121
    v_and_b32 v121, 63, v121
    v_lshlrev_b32 v121, 2, v121
    v_lshl_add_u32 v212, v122, 8, v121
    v_add_u32 v212, 18432, v212
    s_cmp_eq_u32 s3, 0
    s_cselect_b32 s32, 0x2000, 0
    v_mov_b32 v121, 0
    v_writelane_b32 v121, s32, 0
    v_sub_u32 v214, v212, v121
    v_lshl_add_u32 v121, v9, 2, v7
    v_and_b32 v121, 63, v121
    v_lshlrev_b32 v121, 2, v121
    v_lshl_add_u32 v215, v9, 8, v121
    v_add_u32 v215, 18432, v215
    v_cvt_f32_u32 v176, v7
    v_mul_f32 v176, 0x3a000000, v176
    v_cvt_f32_u32 v177, v9
    v_add_f32 v178, 0x00000000, v177
    v_mul_f32 v178, v178, v176
    v_cos_f32 v80, v178
    v_sin_f32 v88, v178
    v_add_f32 v178, 0x3f800000, v177
    v_mul_f32 v178, v178, v176
    v_cos_f32 v81, v178
    v_sin_f32 v89, v178
    v_add_f32 v178, 0x40000000, v177
    v_mul_f32 v178, v178, v176
    v_cos_f32 v82, v178
    v_sin_f32 v90, v178
    v_add_f32 v178, 0x40400000, v177
    v_mul_f32 v178, v178, v176
    v_cos_f32 v83, v178
    v_sin_f32 v91, v178
    v_add_f32 v178, 0x41800000, v177
    v_mul_f32 v178, v178, v176
    v_cos_f32 v84, v178
    v_sin_f32 v92, v178
    v_add_f32 v178, 0x41880000, v177
    v_mul_f32 v178, v178, v176
    v_cos_f32 v85, v178
    v_sin_f32 v93, v178
    v_add_f32 v178, 0x41900000, v177
    v_mul_f32 v178, v178, v176
    v_cos_f32 v86, v178
    v_sin_f32 v94, v178
    v_add_f32 v178, 0x41980000, v177
    v_mul_f32 v178, v178, v176
    v_cos_f32 v87, v178
    v_sin_f32 v95, v178
    s_add_u32 s33, s17, 0x200000
    s_add_u32 s17, s17, 0x202000
    buffer_load_dwordx4 v[112:115], v5, s[20:23], s17 offen
    buffer_load_dwordx4 v[116:119], v5, s[20:23], s17 offen offset:1024
    buffer_load_dwordx4 v[216:219], v5, s[20:23], s33 offen
    buffer_load_dwordx4 v[220:223], v5, s[20:23], s33 offen offset:1024
    v_add_u32 v13, s28, v9
    v_cvt_f32_u32 v177, v13
    v_cvt_f32_u32 v176, v3
    v_mul_f32 v176, 0x3a000000, v176
    v_add_f32 v179, 0x3c000000, v176
    v_add_f32 v178, 0x00000000, v177
    v_mul_f32 v178, v178, v176
    v_cos_f32 v96, v178
    v_sin_f32 v104, v178
    v_add_f32 v178, 0x3f800000, v177
    v_mul_f32 v178, v178, v176
    v_cos_f32 v97, v178
    v_sin_f32 v105, v178
    v_add_f32 v178, 0x40000000, v177
    v_mul_f32 v178, v178, v176
    v_cos_f32 v98, v178
    v_sin_f32 v106, v178
    v_add_f32 v178, 0x40400000, v177
    v_mul_f32 v178, v178, v176
    v_cos_f32 v99, v178
    v_sin_f32 v107, v178
    v_add_f32 v178, 0x00000000, v177
    v_mul_f32 v178, v178, v179
    v_cos_f32 v100, v178
    v_sin_f32 v108, v178
    v_add_f32 v178, 0x3f800000, v177
    v_mul_f32 v178, v178, v179
    v_cos_f32 v101, v178
    v_sin_f32 v109, v178
    v_add_f32 v178, 0x40000000, v177
    v_mul_f32 v178, v178, v179
    v_cos_f32 v102, v178
    v_sin_f32 v110, v178
    v_add_f32 v178, 0x40400000, v177
    v_mul_f32 v178, v178, v179
    v_cos_f32 v103, v178
    v_sin_f32 v111, v178
    v_and_b32 v14, 1, v1
    v_mul_u32_u24 v14, 0x8000, v14
    v_lshl_or_b32 v14, v14, 16, v14
    s_waitcnt lgkmcnt(0)
    v_xor_b32 v32, v16, v14
    v_xor_b32 v33, v17, v14
    v_xor_b32 v34, v18, v14
    v_xor_b32 v35, v19, v14
    v_xor_b32 v36, v20, v14
    v_xor_b32 v37, v21, v14
    v_xor_b32 v38, v22, v14
    v_xor_b32 v39, v23, v14
    v_xor_b32 v40, v24, v14
    v_xor_b32 v41, v25, v14
    v_xor_b32 v42, v26, v14
    v_xor_b32 v43, v27, v14
    v_xor_b32 v44, v28, v14
    v_xor_b32 v45, v29, v14
    v_xor_b32 v46, v30, v14
    v_xor_b32 v47, v31, v14
    v_xor_b32 v56, v48, v14
    v_xor_b32 v57, v49, v14
    v_xor_b32 v58, v50, v14
    v_xor_b32 v59, v51, v14
    v_xor_b32 v60, v52, v14
    v_xor_b32 v61, v53, v14
    v_xor_b32 v62, v54, v14
    v_xor_b32 v63, v55, v14
    v_mov_b32 v64, v48
    v_xor_b32 v65, 0x80008000, v49
    v_mov_b32 v66, v50
    v_xor_b32 v67, 0x80008000, v51
    v_mov_b32 v68, v52
    v_xor_b32 v69, 0x80008000, v53
    v_mov_b32 v70, v54
    v_xor_b32 v71, 0x80008000, v55
    v_mov_b32 v72, v56
    v_xor_b32 v73, 0x80008000, v57
    v_mov_b32 v74, v58
    v_xor_b32 v75, 0x80008000, v59
    v_mov_b32 v76, v60
    v_xor_b32 v77, 0x80008000, v61
    v_mov_b32 v78, v62
    v_xor_b32 v79, 0x80008000, v63
    v_lshlrev_b32 v15, 8, v3
    v_lshl_add_u32 v15, v2, 4, v15
    s_mul_i32 s29, s12, 8320
    s_lshl_b32 s30, s3, 6
    s_add_u32 s29, s29, s30
    s_add_u32 s30, s29, 4096
    s_waitcnt vmcnt(4)
    s_barrier
    ds_read_b128 v[120:123], v5 offset:0
    ds_read_b128 v[124:127], v5 offset:1024
    ds_read_b128 v[128:131], v5 offset:2048
    ds_read_b128 v[132:135], v5 offset:3072
    ds_read_b128 v[136:139], v5 offset:4096
    ds_read_b128 v[140:143], v5 offset:5120
    ds_read_b128 v[144:147], v5 offset:6144
    ds_read_b128 v[148:151], v5 offset:7168
    s_waitcnt vmcnt(0)
    v_lshlrev_b32 v224, 16, v112
    v_and_b32 v225, 0xffff0000, v112
    v_lshlrev_b32 v240, 16, v216
    v_and_b32 v241, 0xffff0000, v216
    v_lshlrev_b32 v226, 16, v113
    v_and_b32 v227, 0xffff0000, v113
    v_lshlrev_b32 v242, 16, v217
    v_and_b32 v243, 0xffff0000, v217
    v_lshlrev_b32 v228, 16, v114
    v_and_b32 v229, 0xffff0000, v114
    v_lshlrev_b32 v244, 16, v218
    v_and_b32 v245, 0xffff0000, v218
    v_lshlrev_b32 v230, 16, v115
    v_and_b32 v231, 0xffff0000, v115
    v_lshlrev_b32 v246, 16, v219
    v_and_b32 v247, 0xffff0000, v219
    v_lshlrev_b32 v232, 16, v116
    v_and_b32 v233, 0xffff0000, v116
    v_lshlrev_b32 v248, 16, v220
    v_and_b32 v249, 0xffff0000, v220
    v_lshlrev_b32 v234, 16, v117
    v_and_b32 v235, 0xffff0000, v117
    v_lshlrev_b32 v250, 16, v221
    v_and_b32 v251, 0xffff0000, v221
    v_lshlrev_b32 v236, 16, v118
    v_and_b32 v237, 0xffff0000, v118
    v_lshlrev_b32 v252, 16, v222
    v_and_b32 v253, 0xffff0000, v222
    v_lshlrev_b32 v238, 16, v119
    v_and_b32 v239, 0xffff0000, v119
    v_lshlrev_b32 v254, 16, v223
    v_and_b32 v255, 0xffff0000, v223
    s_waitcnt lgkmcnt(6)
    v_mfma_f32_16x16x32_bf16 v[152:155], v[120:123], v[16:19], 0
    v_mfma_f32_16x16x32_bf16 v[156:159], v[120:123], v[20:23], 0
    v_mfma_f32_16x16x32_bf16 v[160:163], v[124:127], v[16:19], 0
    v_mfma_f32_16x16x32_bf16 v[164:167], v[124:127], v[20:23], 0
    s_waitcnt lgkmcnt(4)
    v_mfma_f32_16x16x32_bf16 v[152:155], v[128:131], v[24:27], v[152:155]
    v_mfma_f32_16x16x32_bf16 v[156:159], v[128:131], v[28:31], v[156:159]
    v_mfma_f32_16x16x32_bf16 v[160:163], v[132:135], v[24:27], v[160:163]
    v_mfma_f32_16x16x32_bf16 v[164:167], v[132:135], v[28:31], v[164:167]
    s_waitcnt lgkmcnt(2)
    v_mfma_f32_16x16x32_bf16 v[152:155], v[136:139], v[32:35], v[152:155]
    v_mfma_f32_16x16x32_bf16 v[156:159], v[136:139], v[36:39], v[156:159]
    v_mfma_f32_16x16x32_bf16 v[160:163], v[140:143], v[32:35], v[160:163]
    v_mfma_f32_16x16x32_bf16 v[164:167], v[140:143], v[36:39], v[164:167]
    s_waitcnt lgkmcnt(0)
    v_mfma_f32_16x16x32_bf16 v[152:155], v[144:147], v[40:43], v[152:155]
    v_mfma_f32_16x16x32_bf16 v[156:159], v[144:147], v[44:47], v[156:159]
    v_mfma_f32_16x16x32_bf16 v[160:163], v[148:151], v[40:43], v[160:163]
    v_mfma_f32_16x16x32_bf16 v[164:167], v[148:151], v[44:47], v[164:167]
    s_nop 4
    v_pk_mul_f32 v[176:177], v[152:153], v[80:81]
    v_pk_mul_f32 v[180:181], v[156:157], v[80:81]
    v_pk_mul_f32 v[178:179], v[154:155], v[82:83]
    v_pk_mul_f32 v[182:183], v[158:159], v[82:83]
    v_pk_fma_f32 v[176:177], v[156:157], v[88:89], v[176:177]
    v_pk_fma_f32 v[180:181], v[152:153], v[88:89], v[180:181] neg_lo:[1,0,0] neg_hi:[1,0,0]
    v_pk_fma_f32 v[178:179], v[158:159], v[90:91], v[178:179]
    v_pk_fma_f32 v[182:183], v[154:155], v[90:91], v[182:183] neg_lo:[1,0,0] neg_hi:[1,0,0]
    v_cvt_pk_bf16_f32 v168, v176, v180
    v_cvt_pk_bf16_f32 v169, v177, v181
    v_cvt_pk_bf16_f32 v170, v178, v182
    v_cvt_pk_bf16_f32 v171, v179, v183
    v_pk_mul_f32 v[176:177], v[160:161], v[84:85]
    v_pk_mul_f32 v[180:181], v[164:165], v[84:85]
    v_pk_mul_f32 v[178:179], v[162:163], v[86:87]
    v_pk_mul_f32 v[182:183], v[166:167], v[86:87]
    v_pk_fma_f32 v[176:177], v[164:165], v[92:93], v[176:177]
    v_pk_fma_f32 v[180:181], v[160:161], v[92:93], v[180:181] neg_lo:[1,0,0] neg_hi:[1,0,0]
    v_pk_fma_f32 v[178:179], v[166:167], v[94:95], v[178:179]
    v_pk_fma_f32 v[182:183], v[162:163], v[94:95], v[182:183] neg_lo:[1,0,0] neg_hi:[1,0,0]
    v_cvt_pk_bf16_f32 v172, v176, v180
    v_cvt_pk_bf16_f32 v173, v177, v181
    v_cvt_pk_bf16_f32 v174, v178, v182
    v_cvt_pk_bf16_f32 v175, v179, v183
    v_mfma_f32_16x16x32_bf16 v[152:155], v[48:51], v[168:171], 0
    v_mfma_f32_16x16x32_bf16 v[156:159], v[52:55], v[168:171], 0
    v_mfma_f32_16x16x32_bf16 v[160:163], v[64:67], v[168:171], 0
    v_mfma_f32_16x16x32_bf16 v[164:167], v[68:71], v[168:171], 0
    v_mfma_f32_16x16x32_bf16 v[152:155], v[56:59], v[172:175], v[152:155]
    v_mfma_f32_16x16x32_bf16 v[156:159], v[60:63], v[172:175], v[156:159]
    v_mfma_f32_16x16x32_bf16 v[160:163], v[72:75], v[172:175], v[160:163]
    v_mfma_f32_16x16x32_bf16 v[164:167], v[76:79], v[172:175], v[164:167]
    s_waitcnt vmcnt(0)
    s_nop 4
    ds_write2st64_b32 v215, v152, v156 offset0:0 offset1:32
    ds_write2st64_b32 v215, v153, v157 offset0:1 offset1:33
    ds_write2st64_b32 v215, v154, v158 offset0:2 offset1:34
    ds_write2st64_b32 v215, v155, v159 offset0:3 offset1:35
    ds_write2st64_b32 v215, v160, v164 offset0:16 offset1:48
    ds_write2st64_b32 v215, v161, v165 offset0:17 offset1:49
    ds_write2st64_b32 v215, v162, v166 offset0:18 offset1:50
    ds_write2st64_b32 v215, v163, v167 offset0:19 offset1:51
    v_pk_mul_f32 v[176:177], v[152:153], v[224:225] op_sel:[0,0] op_sel_hi:[0,1]
    v_pk_mul_f32 v[178:179], v[152:153], v[226:227] op_sel:[1,0] op_sel_hi:[1,1]
    v_pk_mul_f32 v[180:181], v[154:155], v[228:229] op_sel:[0,0] op_sel_hi:[0,1]
    v_pk_mul_f32 v[182:183], v[154:155], v[230:231] op_sel:[1,0] op_sel_hi:[1,1]
    v_pk_mul_f32 v[184:185], v[160:161], v[232:233] op_sel:[0,0] op_sel_hi:[0,1]
    v_pk_mul_f32 v[186:187], v[160:161], v[234:235] op_sel:[1,0] op_sel_hi:[1,1]
    v_pk_mul_f32 v[188:189], v[162:163], v[236:237] op_sel:[0,0] op_sel_hi:[0,1]
    v_pk_mul_f32 v[190:191], v[162:163], v[238:239] op_sel:[1,0] op_sel_hi:[1,1]
    s_waitcnt lgkmcnt(0)
    s_barrier
    ds_read2st64_b32 v[120:121], v214 offset0:19 offset1:51
    ds_read2st64_b32 v[122:123], v213 offset0:18 offset1:50
    ds_read2st64_b32 v[124:125], v213 offset0:17 offset1:49
    ds_read2st64_b32 v[126:127], v213 offset0:16 offset1:48
    ds_read2st64_b32 v[128:129], v212 offset0:3 offset1:35
    ds_read2st64_b32 v[130:131], v213 offset0:2 offset1:34
    ds_read2st64_b32 v[132:133], v213 offset0:1 offset1:33
    ds_read2st64_b32 v[134:135], v213 offset0:0 offset1:32
    v_pk_fma_f32 v[176:177], v[156:157], v[224:225], v[176:177] op_sel:[0,1,0] op_sel_hi:[0,0,1] neg_lo:[0,1,0]
    v_pk_fma_f32 v[178:179], v[156:157], v[226:227], v[178:179] op_sel:[1,1,0] op_sel_hi:[1,0,1] neg_lo:[0,1,0]
    v_pk_fma_f32 v[180:181], v[158:159], v[228:229], v[180:181] op_sel:[0,1,0] op_sel_hi:[0,0,1] neg_lo:[0,1,0]
    v_pk_fma_f32 v[182:183], v[158:159], v[230:231], v[182:183] op_sel:[1,1,0] op_sel_hi:[1,0,1] neg_lo:[0,1,0]
    v_pk_fma_f32 v[184:185], v[164:165], v[232:233], v[184:185] op_sel:[0,1,0] op_sel_hi:[0,0,1] neg_lo:[0,1,0]
    v_pk_fma_f32 v[186:187], v[164:165], v[234:235], v[186:187] op_sel:[1,1,0] op_sel_hi:[1,0,1] neg_lo:[0,1,0]
    v_pk_fma_f32 v[188:189], v[166:167], v[236:237], v[188:189] op_sel:[0,1,0] op_sel_hi:[0,0,1] neg_lo:[0,1,0]
    v_pk_fma_f32 v[190:191], v[166:167], v[238:239], v[190:191] op_sel:[1,1,0] op_sel_hi:[1,0,1] neg_lo:[0,1,0]
    s_waitcnt lgkmcnt(4)
    v_pk_fma_f32 v[176:177], v[120:121], v[240:241], v[176:177] op_sel:[0,0,0] op_sel_hi:[0,1,1]
    v_pk_fma_f32 v[178:179], v[122:123], v[242:243], v[178:179] op_sel:[0,0,0] op_sel_hi:[0,1,1]
    v_pk_fma_f32 v[180:181], v[124:125], v[244:245], v[180:181] op_sel:[0,0,0] op_sel_hi:[0,1,1]
    v_pk_fma_f32 v[182:183], v[126:127], v[246:247], v[182:183] op_sel:[0,0,0] op_sel_hi:[0,1,1]
    v_pk_fma_f32 v[176:177], v[120:121], v[240:241], v[176:177] op_sel:[1,1,0] op_sel_hi:[1,0,1] neg_hi:[0,1,0]
    v_pk_fma_f32 v[178:179], v[122:123], v[242:243], v[178:179] op_sel:[1,1,0] op_sel_hi:[1,0,1] neg_hi:[0,1,0]
    v_pk_fma_f32 v[180:181], v[124:125], v[244:245], v[180:181] op_sel:[1,1,0] op_sel_hi:[1,0,1] neg_hi:[0,1,0]
    v_pk_fma_f32 v[182:183], v[126:127], v[246:247], v[182:183] op_sel:[1,1,0] op_sel_hi:[1,0,1] neg_hi:[0,1,0]
    s_waitcnt lgkmcnt(0)
    v_pk_fma_f32 v[184:185], v[128:129], v[248:249], v[184:185] op_sel:[0,0,0] op_sel_hi:[0,1,1]
    v_pk_fma_f32 v[186:187], v[130:131], v[250:251], v[186:187] op_sel:[0,0,0] op_sel_hi:[0,1,1]
    v_pk_fma_f32 v[188:189], v[132:133], v[252:253], v[188:189] op_sel:[0,0,0] op_sel_hi:[0,1,1]
    v_pk_fma_f32 v[190:191], v[134:135], v[254:255], v[190:191] op_sel:[0,0,0] op_sel_hi:[0,1,1]
    v_pk_fma_f32 v[184:185], v[128:129], v[248:249], v[184:185] op_sel:[1,1,0] op_sel_hi:[1,0,1] neg_hi:[0,1,0]
    v_pk_fma_f32 v[186:187], v[130:131], v[250:251], v[186:187] op_sel:[1,1,0] op_sel_hi:[1,0,1] neg_hi:[0,1,0]
    v_pk_fma_f32 v[188:189], v[132:133], v[252:253], v[188:189] op_sel:[1,1,0] op_sel_hi:[1,0,1] neg_hi:[0,1,0]
    v_pk_fma_f32 v[190:191], v[134:135], v[254:255], v[190:191] op_sel:[1,1,0] op_sel_hi:[1,0,1] neg_hi:[0,1,0]
    v_cvt_pk_bf16_f32 v168, v176, -v177
    v_cvt_pk_bf16_f32 v169, v178, -v179
    v_cvt_pk_bf16_f32 v170, v180, -v181
    v_cvt_pk_bf16_f32 v171, v182, -v183
    v_cvt_pk_bf16_f32 v172, v184, -v185
    v_cvt_pk_bf16_f32 v173, v186, -v187
    v_cvt_pk_bf16_f32 v174, v188, -v189
    v_cvt_pk_bf16_f32 v175, v190, -v191
    v_mfma_f32_16x16x32_bf16 v[152:155], v[168:171], v[48:51], 0
    v_mfma_f32_16x16x32_bf16 v[156:159], v[168:171], v[52:55], 0
    v_mfma_f32_16x16x32_bf16 v[160:163], v[168:171], v[64:67], 0
    v_mfma_f32_16x16x32_bf16 v[164:167], v[168:171], v[68:71], 0
    v_mfma_f32_16x16x32_bf16 v[152:155], v[172:175], v[56:59], v[152:155]
    v_mfma_f32_16x16x32_bf16 v[156:159], v[172:175], v[60:63], v[156:159]
    v_mfma_f32_16x16x32_bf16 v[160:163], v[172:175], v[72:75], v[160:163]
    v_mfma_f32_16x16x32_bf16 v[164:167], v[172:175], v[76:79], v[164:167]
    s_nop 4
    v_pk_mul_f32 v[176:177], v[152:153], v[96:97]
    v_pk_mul_f32 v[180:181], v[156:157], v[96:97]
    v_pk_mul_f32 v[178:179], v[154:155], v[98:99]
    v_pk_mul_f32 v[182:183], v[158:159], v[98:99]
    v_pk_fma_f32 v[176:177], v[156:157], v[104:105], v[176:177]
    v_pk_fma_f32 v[180:181], v[152:153], v[104:105], v[180:181] neg_lo:[1,0,0] neg_hi:[1,0,0]
    v_pk_fma_f32 v[178:179], v[158:159], v[106:107], v[178:179]
    v_pk_fma_f32 v[182:183], v[154:155], v[106:107], v[182:183] neg_lo:[1,0,0] neg_hi:[1,0,0]
    v_cvt_pk_bf16_f32 v168, v176, v180
    v_cvt_pk_bf16_f32 v169, v177, v181
    v_cvt_pk_bf16_f32 v170, v178, v182
    v_cvt_pk_bf16_f32 v171, v179, v183
    v_pk_mul_f32 v[176:177], v[160:161], v[100:101]
    v_pk_mul_f32 v[180:181], v[164:165], v[100:101]
    v_pk_mul_f32 v[178:179], v[162:163], v[102:103]
    v_pk_mul_f32 v[182:183], v[166:167], v[102:103]
    v_pk_fma_f32 v[176:177], v[164:165], v[108:109], v[176:177]
    v_pk_fma_f32 v[180:181], v[160:161], v[108:109], v[180:181] neg_lo:[1,0,0] neg_hi:[1,0,0]
    v_pk_fma_f32 v[178:179], v[166:167], v[110:111], v[178:179]
    v_pk_fma_f32 v[182:183], v[162:163], v[110:111], v[182:183] neg_lo:[1,0,0] neg_hi:[1,0,0]
    v_cvt_pk_bf16_f32 v172, v176, v180
    v_cvt_pk_bf16_f32 v173, v177, v181
    v_cvt_pk_bf16_f32 v174, v178, v182
    v_cvt_pk_bf16_f32 v175, v179, v183
    s_add_u32 s31, s16, 8192
    v_add_u32 v4, s31, v5
    ds_write_b128 v4, v[168:171]
    ds_write_b128 v4, v[172:175] offset:1024
    s_waitcnt lgkmcnt(0)
    s_barrier
    ds_read_b128 v[120:123], v5 offset:8192
    ds_read_b128 v[124:127], v5 offset:9216
    ds_read_b128 v[128:131], v5 offset:10240
    ds_read_b128 v[132:135], v5 offset:11264
    ds_read_b128 v[136:139], v5 offset:12288
    ds_read_b128 v[140:143], v5 offset:13312
    ds_read_b128 v[144:147], v5 offset:14336
    ds_read_b128 v[148:151], v5 offset:15360
    s_waitcnt lgkmcnt(6)
    v_mfma_f32_16x16x32_bf16 v[152:155], v[16:19], v[120:123], 0
    v_mfma_f32_16x16x32_bf16 v[156:159], v[20:23], v[120:123], 0
    v_mfma_f32_16x16x32_bf16 v[160:163], v[16:19], v[124:127], 0
    v_mfma_f32_16x16x32_bf16 v[164:167], v[20:23], v[124:127], 0
    s_waitcnt lgkmcnt(4)
    v_mfma_f32_16x16x32_bf16 v[152:155], v[24:27], v[128:131], v[152:155]
    v_mfma_f32_16x16x32_bf16 v[156:159], v[28:31], v[128:131], v[156:159]
    v_mfma_f32_16x16x32_bf16 v[160:163], v[24:27], v[132:135], v[160:163]
    v_mfma_f32_16x16x32_bf16 v[164:167], v[28:31], v[132:135], v[164:167]
    s_waitcnt lgkmcnt(2)
    v_mfma_f32_16x16x32_bf16 v[152:155], v[32:35], v[136:139], v[152:155]
    v_mfma_f32_16x16x32_bf16 v[156:159], v[36:39], v[136:139], v[156:159]
    v_mfma_f32_16x16x32_bf16 v[160:163], v[32:35], v[140:143], v[160:163]
    v_mfma_f32_16x16x32_bf16 v[164:167], v[36:39], v[140:143], v[164:167]
    s_waitcnt lgkmcnt(0)
    v_mfma_f32_16x16x32_bf16 v[152:155], v[40:43], v[144:147], v[152:155]
    v_mfma_f32_16x16x32_bf16 v[156:159], v[44:47], v[144:147], v[156:159]
    v_mfma_f32_16x16x32_bf16 v[160:163], v[40:43], v[148:151], v[160:163]
    v_mfma_f32_16x16x32_bf16 v[164:167], v[44:47], v[148:151], v[164:167]
    s_nop 5
    v_cvt_pk_bf16_f32 v168, v152, -v156
    v_cvt_pk_bf16_f32 v169, v153, -v157
    v_cvt_pk_bf16_f32 v170, v154, -v158
    v_cvt_pk_bf16_f32 v171, v155, -v159
    buffer_store_dwordx4 v[168:171], v15, s[24:27], s29 offen
    v_cvt_pk_bf16_f32 v172, v160, -v164
    v_cvt_pk_bf16_f32 v173, v161, -v165
    v_cvt_pk_bf16_f32 v174, v162, -v166
    v_cvt_pk_bf16_f32 v175, v163, -v167
    buffer_store_dwordx4 v[172:175], v15, s[24:27], s30 offen
    s_endpgm

.globl k3_kernel
.p2align 8
.type k3_kernel,@function
k3_kernel:
    s_cmp_ge_u32 s2, 256
    s_cbranch_scc1 K3_END
    s_load_dwordx2 s[4:5], s[0:1], 80
    s_load_dwordx2 s[6:7], s[0:1], 0
    s_load_dwordx2 s[44:45], s[0:1], 32
    v_and_b32 v1, 63, v0
    v_lshrrev_b32 v2, 6, v0
    s_and_b32 s12, s2, 7
    s_lshr_b32 s13, s2, 3
    v_readfirstlane_b32 s3, v2
    s_lshl_b32 s12, s12, 2
    s_lshr_b32 s14, s13, 3
    s_add_u32 s12, s12, s14
    s_and_b32 s13, s13, 7
    s_lshl_b32 s14, s12, 8
    s_lshl_b32 s15, s13, 5
    s_add_u32 s14, s14, s15
    v_mul_u32_u24 v4, 8320, v0
    s_lshl_b32 s15, s13, 8
    s_lshl_b32 s16, s3, 6
    s_add_u32 s15, s15, s16
    s_add_u32 s15, s15, s12
    s_lshl_b32 s15, s15, 10
    s_add_u32 s16, s15, 32768
    v_lshrrev_b32 v2, 4, v1
    v_and_b32 v3, 15, v1
    v_lshlrev_b32 v5, 5, v3
    v_lshl_add_u32 v5, v2, 3, v5
    s_lshl_b32 s17, s3, 3
    s_add_u32 s17, s17, s14
    v_cvt_f32_u32 v6, v2
    v_cvt_f32_u32 v7, v3
    v_mul_f32 v96, 0xbd800000, v7
    v_add_f32 v97, v6, v6
    v_add_f32 v98, 1.0, v97
    v_mul_f32 v99, v96, v97
    v_mul_f32 v100, v96, v98
    v_add_f32 v101, 0x3e800000, v99
    v_add_f32 v102, 0x3e800000, v100
    v_cos_f32 v104, v99
    v_sin_f32 v108, v99
    v_cos_f32 v105, v100
    v_sin_f32 v109, v100
    v_cos_f32 v106, v101
    v_sin_f32 v110, v101
    v_cos_f32 v107, v102
    v_sin_f32 v111, v102
    v_cvt_pk_bf16_f32 v24, v104, v108
    v_cvt_pk_bf16_f32 v25, v105, v109
    v_cvt_pk_bf16_f32 v26, v106, v110
    v_cvt_pk_bf16_f32 v27, v107, v111
    s_lshr_b32 s56, s2, 3
    s_lshl_b32 s56, s56, 2
    s_add_u32 s56, s56, s3
    s_and_b32 s57, s2, 7
    s_mul_i32 s57, s57, 116
    s_add_u32 s57, s57, s56
    s_lshr_b32 s58, s57, 5
    s_bfe_u32 s59, s57, 0x40001
    s_and_b32 s57, s57, 1
    s_lshl_b32 s63, s58, 6
    s_lshl_b32 s62, s59, 1
    s_add_u32 s63, s63, s62
    s_add_u32 s63, s63, s57
    s_add_u32 s63, s63, 32
    s_mul_i32 s63, s63, 3072
    s_lshl_b32 s57, s57, 10
    s_add_u32 s57, s57, s59
    s_add_u32 s57, s57, 16
    s_mul_i32 s62, s57, 2752
    s_mul_i32 s58, s58, 96
    s_add_u32 s62, s62, s58
    s_cmp_ge_u32 s56, 116
    s_cselect_b32 s62, 0x7000000, s62
    s_cselect_b32 s63, 0x7000000, s63
    v_add_u32 v148, 0, v1
    v_mul_u32_u24 v149, 171, v148
    v_lshrrev_b32 v149, 10, v149
    v_mul_u32_u24 v150, 6, v149
    v_sub_u32 v148, v148, v150
    v_bfe_u32 v150, v149, 2, 2
    v_lshlrev_b32 v150, 8, v150
    v_lshrrev_b32 v144, 4, v149
    v_lshl_add_u32 v150, v144, 7, v150
    v_and_b32 v149, 3, v149
    v_lshl_add_u32 v150, v149, 5, v150
    v_mul_u32_u24 v150, 2752, v150
    v_lshl_add_u32 v144, v148, 4, v150
    v_add_u32 v148, 64, v1
    v_mul_u32_u24 v149, 171, v148
    v_lshrrev_b32 v149, 10, v149
    v_mul_u32_u24 v150, 6, v149
    v_sub_u32 v148, v148, v150
    v_bfe_u32 v150, v149, 2, 2
    v_lshlrev_b32 v150, 8, v150
    v_lshrrev_b32 v145, 4, v149
    v_lshl_add_u32 v150, v145, 7, v150
    v_and_b32 v149, 3, v149
    v_lshl_add_u32 v150, v149, 5, v150
    v_mul_u32_u24 v150, 2752, v150
    v_lshl_add_u32 v145, v148, 4, v150
    v_add_u32 v148, 128, v1
    v_mul_u32_u24 v149, 171, v148
    v_lshrrev_b32 v149, 10, v149
    v_mul_u32_u24 v150, 6, v149
    v_sub_u32 v148, v148, v150
    v_bfe_u32 v150, v149, 2, 2
    v_lshlrev_b32 v150, 8, v150
    v_lshrrev_b32 v146, 4, v149
    v_lshl_add_u32 v150, v146, 7, v150
    v_and_b32 v149, 3, v149
    v_lshl_add_u32 v150, v149, 5, v150
    v_mul_u32_u24 v150, 2752, v150
    v_lshl_add_u32 v146, v148, 4, v150
    v_lshlrev_b32 v147, 4, v1
    s_waitcnt lgkmcnt(0)
    s_add_u32 s8, s4, 0x600000
    s_addc_u32 s9, s5, 0
    s_and_b32 s9, s9, 0xffff
    s_mov_b32 s10, 0x20a080
    s_mov_b32 s11, 0x20000
    buffer_load_dwordx4 v[8:11], v4, s[8:11], s14 offen
    buffer_load_dwordx4 v[12:15], v4, s[8:11], s14 offen offset:16
    s_mov_b32 s20, s6
    s_and_b32 s21, s7, 0xffff
    s_mov_b32 s22, 0x200000
    s_mov_b32 s23, 0x20000
    buffer_load_dwordx2 v[16:17], v5, s[20:23], s15 offen offset:0
    buffer_load_dwordx2 v[18:19], v5, s[20:23], s15 offen offset:512
    buffer_load_dwordx2 v[20:21], v5, s[20:23], s16 offen offset:0
    buffer_load_dwordx2 v[22:23], v5, s[20:23], s16 offen offset:512
    s_add_u32 s24, s4, 0x600000
    s_addc_u32 s25, s5, 0
    s_add_u32 s24, s24, s17
    s_addc_u32 s25, s25, 0
    s_load_dwordx2 s[26:27], s[24:25], 0
    s_add_u32 s32, s4, 0x900000
    s_addc_u32 s33, s5, 0
    s_and_b32 s33, s33, 0xffff
    s_mov_b32 s34, 0x200000
    s_mov_b32 s35, 0x20000
    s_add_u32 s36, s4, 0xc00000
    s_addc_u32 s37, s5, 0
    s_and_b32 s37, s37, 0xffff
    s_mov_b32 s38, 0x200000
    s_mov_b32 s39, 0x20000
    s_mov_b32 s48, s44
    s_and_b32 s49, s45, 0xffff
    s_mov_b32 s50, 0x560000
    s_mov_b32 s51, 0x20000
    s_add_u32 s52, s4, 0x1100000
    s_addc_u32 s53, s5, 0
    s_and_b32 s53, s53, 0xffff
    s_mov_b32 s54, 0x570000
    s_mov_b32 s55, 0x20000
    v_mul_f32 v96, 0x3b000000, v7
    v_mul_f32 v97, 4.0, v6
    v_add_f32 v98, 0x00000000, v97
    v_mul_f32 v98, v98, v96
    v_cos_f32 v28, v98
    v_sin_f32 v36, v98
    v_add_f32 v98, 0x3f800000, v97
    v_mul_f32 v98, v98, v96
    v_cos_f32 v29, v98
    v_sin_f32 v37, v98
    v_add_f32 v98, 0x40000000, v97
    v_mul_f32 v98, v98, v96
    v_cos_f32 v30, v98
    v_sin_f32 v38, v98
    v_add_f32 v98, 0x40400000, v97
    v_mul_f32 v98, v98, v96
    v_cos_f32 v31, v98
    v_sin_f32 v39, v98
    v_add_f32 v98, 0x41800000, v97
    v_mul_f32 v98, v98, v96
    v_cos_f32 v32, v98
    v_sin_f32 v40, v98
    v_add_f32 v98, 0x41880000, v97
    v_mul_f32 v98, v98, v96
    v_cos_f32 v33, v98
    v_sin_f32 v41, v98
    v_add_f32 v98, 0x41900000, v97
    v_mul_f32 v98, v98, v96
    v_cos_f32 v34, v98
    v_sin_f32 v42, v98
    v_add_f32 v98, 0x41980000, v97
    v_mul_f32 v98, v98, v96
    v_cos_f32 v35, v98
    v_sin_f32 v43, v98
    v_mul_f32 v96, 0x3d000000, v7
    v_add_f32 v98, 0x00000000, v97
    v_mul_f32 v98, v98, v96
    v_cos_f32 v99, v98
    v_sin_f32 v100, v98
    s_nop 0
    v_cvt_pk_bf16_f32 v44, v99, -v100
    v_add_f32 v98, 0x3f800000, v97
    v_mul_f32 v98, v98, v96
    v_cos_f32 v99, v98
    v_sin_f32 v100, v98
    s_nop 0
    v_cvt_pk_bf16_f32 v45, v99, -v100
    v_add_f32 v98, 0x40000000, v97
    v_mul_f32 v98, v98, v96
    v_cos_f32 v99, v98
    v_sin_f32 v100, v98
    s_nop 0
    v_cvt_pk_bf16_f32 v46, v99, -v100
    v_add_f32 v98, 0x40400000, v97
    v_mul_f32 v98, v98, v96
    v_cos_f32 v99, v98
    v_sin_f32 v100, v98
    s_nop 0
    v_cvt_pk_bf16_f32 v47, v99, -v100
    v_and_b32 v101, 1, v1
    v_mul_u32_u24 v101, 0x8000, v101
    v_lshl_or_b32 v101, v101, 16, v101
    v_xor_b32 v48, v44, v101
    v_xor_b32 v49, v45, v101
    v_xor_b32 v50, v46, v101
    v_xor_b32 v51, v47, v101
    v_mov_b32 v52, v44
    v_xor_b32 v53, 0x80008000, v45
    v_mov_b32 v54, v46
    v_xor_b32 v55, 0x80008000, v47
    v_mov_b32 v56, v48
    v_xor_b32 v57, 0x80008000, v49
    v_mov_b32 v58, v50
    v_xor_b32 v59, 0x80008000, v51
    v_lshrrev_b32 v60, 6, v0
    v_mul_u32_u24 v60, 80, v60
    v_add_u32 v60, v60, v1
    v_lshlrev_b32 v60, 2, v60
    v_mul_u32_u24 v61, 80, v2
    v_add_u32 v61, v61, v3
    v_lshlrev_b32 v61, 2, v61
    s_mul_i32 s18, s3, 2560
    v_add_u32 v61, s18, v61
    s_mul_i32 s19, s3, 2176
    s_add_u32 s19, s19, 10240
    v_add_u32 v62, s19, v5
    v_lshrrev_b32 v63, 2, v3
    v_mul_u32_u24 v63, 1088, v63
    v_lshl_add_u32 v63, v2, 5, v63
    v_and_b32 v96, 3, v1
    v_lshl_add_u32 v63, v96, 3, v63
    s_lshl_b32 s30, s3, 8
    s_add_u32 s30, s30, 10240
    v_add_u32 v63, s30, v63
    s_waitcnt vmcnt(4)
    buffer_load_dwordx4 v[132:135], v144, s[48:51], s62 offen
    buffer_load_dwordx4 v[136:139], v145, s[48:51], s62 offen
    buffer_load_dwordx4 v[140:143], v146, s[48:51], s62 offen
    ds_write2st64_b32 v60, v8, v9 offset0:0 offset1:5
    ds_write2st64_b32 v60, v10, v11 offset0:10 offset1:15
    ds_write2st64_b32 v60, v12, v13 offset0:20 offset1:25
    ds_write2st64_b32 v60, v14, v15 offset0:30 offset1:35
    s_waitcnt lgkmcnt(0)
    s_barrier
    ds_read2_b32 v[64:65], v61 offset0:0 offset1:32
    ds_read2_b32 v[66:67], v61 offset0:16 offset1:48
    v_add_u32 v97, 1280, v61
    ds_read2_b32 v[68:69], v97 offset0:0 offset1:32
    ds_read2_b32 v[70:71], v97 offset0:16 offset1:48
    s_and_b32 s28, s26, 0xffff0000
    s_lshl_b32 s26, s26, 16
    s_and_b32 s29, s27, 0xffff0000
    s_lshl_b32 s27, s27, 16
    v_mov_b32 v98, s28
    v_mov_b32 v99, s29
    v_subrev_f32 v8, s26, v98
    v_sub_f32_e64 v9, -v98, s26
    v_subrev_f32 v10, s27, v99
    v_sub_f32_e64 v11, -v99, s27
    v_mul_f32 v8, 0x35800000, v8
    v_mul_f32 v9, 0x35800000, v9
    v_mul_f32 v10, 0x35800000, v10
    v_mul_f32 v11, 0x35800000, v11
    s_waitcnt lgkmcnt(2)
    v_mfma_f32_16x16x16_bf16 v[72:75], v[64:65], v[24:25], 0
    v_mfma_f32_16x16x16_bf16 v[76:79], v[64:65], v[26:27], 0
    v_mfma_f32_16x16x16_bf16 v[80:83], v[66:67], v[24:25], 0
    v_mfma_f32_16x16x16_bf16 v[84:87], v[66:67], v[26:27], 0
    s_waitcnt lgkmcnt(0)
    v_mfma_f32_16x16x16_bf16 v[88:91], v[68:69], v[24:25], 0
    v_mfma_f32_16x16x16_bf16 v[92:95], v[68:69], v[26:27], 0
    v_mfma_f32_16x16x16_bf16 v[96:99], v[70:71], v[24:25], 0
    v_mfma_f32_16x16x16_bf16 v[100:103], v[70:71], v[26:27], 0
    v_pk_mul_f32 v[120:121], v[72:73], v[28:29]
    v_pk_mul_f32 v[124:125], v[76:77], v[28:29]
    v_pk_mul_f32 v[122:123], v[74:75], v[30:31]
    v_pk_mul_f32 v[126:127], v[78:79], v[30:31]
    v_pk_fma_f32 v[120:121], v[76:77], v[36:37], v[120:121] neg_lo:[1,0,0] neg_hi:[1,0,0]
    v_pk_fma_f32 v[124:125], v[72:73], v[36:37], v[124:125]
    v_pk_fma_f32 v[122:123], v[78:79], v[38:39], v[122:123] neg_lo:[1,0,0] neg_hi:[1,0,0]
    v_pk_fma_f32 v[126:127], v[74:75], v[38:39], v[126:127]
    v_cvt_pk_bf16_f32 v104, v120, v124
    v_cvt_pk_bf16_f32 v105, v121, v125
    v_cvt_pk_bf16_f32 v106, v122, v126
    v_cvt_pk_bf16_f32 v107, v123, v127
    v_pk_mul_f32 v[120:121], v[80:81], v[32:33]
    v_pk_mul_f32 v[124:125], v[84:85], v[32:33]
    v_pk_mul_f32 v[122:123], v[82:83], v[34:35]
    v_pk_mul_f32 v[126:127], v[86:87], v[34:35]
    v_pk_fma_f32 v[120:121], v[84:85], v[40:41], v[120:121] neg_lo:[1,0,0] neg_hi:[1,0,0]
    v_pk_fma_f32 v[124:125], v[80:81], v[40:41], v[124:125]
    v_pk_fma_f32 v[122:123], v[86:87], v[42:43], v[122:123] neg_lo:[1,0,0] neg_hi:[1,0,0]
    v_pk_fma_f32 v[126:127], v[82:83], v[42:43], v[126:127]
    v_cvt_pk_bf16_f32 v108, v120, v124
    v_cvt_pk_bf16_f32 v109, v121, v125
    v_cvt_pk_bf16_f32 v110, v122, v126
    v_cvt_pk_bf16_f32 v111, v123, v127
    v_pk_mul_f32 v[120:121], v[88:89], v[28:29]
    v_pk_mul_f32 v[124:125], v[92:93], v[28:29]
    v_pk_mul_f32 v[122:123], v[90:91], v[30:31]
    v_pk_mul_f32 v[126:127], v[94:95], v[30:31]
    v_pk_fma_f32 v[120:121], v[92:93], v[36:37], v[120:121] neg_lo:[1,0,0] neg_hi:[1,0,0]
    v_pk_fma_f32 v[124:125], v[88:89], v[36:37], v[124:125]
    v_pk_fma_f32 v[122:123], v[94:95], v[38:39], v[122:123] neg_lo:[1,0,0] neg_hi:[1,0,0]
    v_pk_fma_f32 v[126:127], v[90:91], v[38:39], v[126:127]
    v_cvt_pk_bf16_f32 v112, v120, v124
    v_cvt_pk_bf16_f32 v113, v121, v125
    v_cvt_pk_bf16_f32 v114, v122, v126
    v_cvt_pk_bf16_f32 v115, v123, v127
    v_pk_mul_f32 v[120:121], v[96:97], v[32:33]
    v_pk_mul_f32 v[124:125], v[100:101], v[32:33]
    v_pk_mul_f32 v[122:123], v[98:99], v[34:35]
    v_pk_mul_f32 v[126:127], v[102:103], v[34:35]
    v_pk_fma_f32 v[120:121], v[100:101], v[40:41], v[120:121] neg_lo:[1,0,0] neg_hi:[1,0,0]
    v_pk_fma_f32 v[124:125], v[96:97], v[40:41], v[124:125]
    v_pk_fma_f32 v[122:123], v[102:103], v[42:43], v[122:123] neg_lo:[1,0,0] neg_hi:[1,0,0]
    v_pk_fma_f32 v[126:127], v[98:99], v[42:43], v[126:127]
    v_cvt_pk_bf16_f32 v116, v120, v124
    v_cvt_pk_bf16_f32 v117, v121, v125
    v_cvt_pk_bf16_f32 v118, v122, v126
    v_cvt_pk_bf16_f32 v119, v123, v127
    v_mfma_f32_16x16x32_bf16 v[72:75], v[104:107], v[44:47], 0
    v_mfma_f32_16x16x32_bf16 v[76:79], v[104:107], v[52:55], 0
    v_mfma_f32_16x16x32_bf16 v[80:83], v[112:115], v[44:47], 0
    v_mfma_f32_16x16x32_bf16 v[84:87], v[112:115], v[52:55], 0
    v_mfma_f32_16x16x32_bf16 v[72:75], v[108:111], v[48:51], v[72:75]
    v_mfma_f32_16x16x32_bf16 v[76:79], v[108:111], v[56:59], v[76:79]
    v_mfma_f32_16x16x32_bf16 v[80:83], v[116:119], v[48:51], v[80:83]
    v_mfma_f32_16x16x32_bf16 v[84:87], v[116:119], v[56:59], v[84:87]
    v_mov_b32 v12, 0x36000000
    s_waitcnt vmcnt(3)
    v_lshlrev_b32 v88, 16, v16
    v_and_b32 v89, 0xffff0000, v16
    v_lshlrev_b32 v90, 16, v17
    v_and_b32 v91, 0xffff0000, v17
    v_lshlrev_b32 v92, 16, v18
    v_and_b32 v93, 0xffff0000, v18
    v_lshlrev_b32 v94, 16, v19
    v_and_b32 v95, 0xffff0000, v19
    v_lshlrev_b32 v96, 16, v20
    v_and_b32 v97, 0xffff0000, v20
    v_lshlrev_b32 v98, 16, v21
    v_and_b32 v99, 0xffff0000, v21
    v_lshlrev_b32 v100, 16, v22
    v_and_b32 v101, 0xffff0000, v22
    v_lshlrev_b32 v102, 16, v23
    v_and_b32 v103, 0xffff0000, v23
    v_pk_add_f32 v[88:89], v[88:89], v[8:9]
    v_pk_add_f32 v[96:97], v[96:97], v[10:11]
    v_pk_add_f32 v[90:91], v[90:91], v[8:9]
    v_pk_add_f32 v[98:99], v[98:99], v[10:11]
    v_pk_add_f32 v[92:93], v[92:93], v[8:9]
    v_pk_add_f32 v[100:101], v[100:101], v[10:11]
    v_pk_add_f32 v[94:95], v[94:95], v[8:9]
    v_pk_add_f32 v[102:103], v[102:103], v[10:11]
    v_pk_fma_f32 v[72:73], v[72:73], v[12:13], v[88:89] op_sel_hi:[1,0,1]
    v_pk_fma_f32 v[80:81], v[80:81], v[12:13], v[96:97] op_sel_hi:[1,0,1]
    v_pk_fma_f32 v[74:75], v[74:75], v[12:13], v[90:91] op_sel_hi:[1,0,1]
    v_pk_fma_f32 v[82:83], v[82:83], v[12:13], v[98:99] op_sel_hi:[1,0,1]
    v_pk_fma_f32 v[76:77], v[76:77], v[12:13], v[92:93] op_sel_hi:[1,0,1]
    v_pk_fma_f32 v[84:85], v[84:85], v[12:13], v[100:101] op_sel_hi:[1,0,1]
    v_pk_fma_f32 v[78:79], v[78:79], v[12:13], v[94:95] op_sel_hi:[1,0,1]
    v_pk_fma_f32 v[86:87], v[86:87], v[12:13], v[102:103] op_sel_hi:[1,0,1]
    v_cvt_pk_bf16_f32 v24, v72, v73
    v_cvt_pk_bf16_f32 v25, v74, v75
    v_cvt_pk_bf16_f32 v26, v76, v77
    v_cvt_pk_bf16_f32 v27, v78, v79
    v_cvt_pk_bf16_f32 v28, v80, v81
    v_cvt_pk_bf16_f32 v29, v82, v83
    v_cvt_pk_bf16_f32 v30, v84, v85
    v_cvt_pk_bf16_f32 v31, v86, v87
    buffer_store_dwordx2 v[24:25], v5, s[32:35], s15 offen offset:0 sc0 sc1
    buffer_store_dwordx2 v[26:27], v5, s[32:35], s15 offen offset:512 sc0 sc1
    buffer_store_dwordx2 v[28:29], v5, s[32:35], s16 offen offset:0 sc0 sc1
    buffer_store_dwordx2 v[30:31], v5, s[32:35], s16 offen offset:512 sc0 sc1
    v_lshlrev_b32 v72, 16, v24
    v_and_b32 v73, 0xffff0000, v24
    v_lshlrev_b32 v74, 16, v25
    v_and_b32 v75, 0xffff0000, v25
    v_lshlrev_b32 v76, 16, v26
    v_and_b32 v77, 0xffff0000, v26
    v_lshlrev_b32 v78, 16, v27
    v_and_b32 v79, 0xffff0000, v27
    v_lshlrev_b32 v80, 16, v28
    v_and_b32 v81, 0xffff0000, v28
    v_lshlrev_b32 v82, 16, v29
    v_and_b32 v83, 0xffff0000, v29
    v_lshlrev_b32 v84, 16, v30
    v_and_b32 v85, 0xffff0000, v30
    v_lshlrev_b32 v86, 16, v31
    v_and_b32 v87, 0xffff0000, v31
    v_readfirstlane_b32 s40, v72
    v_readfirstlane_b32 s42, v80
    v_mov_b32 v124, 0x3b000000
    v_pk_add_f32 v[88:89], v[72:73], s[40:41] op_sel_hi:[1,0] neg_lo:[0,1] neg_hi:[0,1]
    v_pk_add_f32 v[96:97], v[80:81], s[42:43] op_sel_hi:[1,0] neg_lo:[0,1] neg_hi:[0,1]
    v_pk_add_f32 v[90:91], v[74:75], s[40:41] op_sel_hi:[1,0] neg_lo:[0,1] neg_hi:[0,1]
    v_pk_add_f32 v[98:99], v[82:83], s[42:43] op_sel_hi:[1,0] neg_lo:[0,1] neg_hi:[0,1]
    v_pk_add_f32 v[92:93], v[76:77], s[40:41] op_sel_hi:[1,0] neg_lo:[0,1] neg_hi:[0,1]
    v_pk_add_f32 v[100:101], v[84:85], s[42:43] op_sel_hi:[1,0] neg_lo:[0,1] neg_hi:[0,1]
    v_pk_add_f32 v[94:95], v[78:79], s[40:41] op_sel_hi:[1,0] neg_lo:[0,1] neg_hi:[0,1]
    v_pk_add_f32 v[102:103], v[86:87], s[42:43] op_sel_hi:[1,0] neg_lo:[0,1] neg_hi:[0,1]
    v_pk_add_f32 v[104:105], v[88:89], v[90:91]
    v_pk_mul_f32 v[112:113], v[88:89], v[88:89]
    v_pk_add_f32 v[106:107], v[92:93], v[94:95]
    v_pk_mul_f32 v[114:115], v[92:93], v[92:93]
    v_pk_add_f32 v[108:109], v[96:97], v[98:99]
    v_pk_mul_f32 v[116:117], v[96:97], v[96:97]
    v_pk_add_f32 v[110:111], v[100:101], v[102:103]
    v_pk_mul_f32 v[118:119], v[100:101], v[100:101]
    v_pk_fma_f32 v[112:113], v[90:91], v[90:91], v[112:113]
    v_pk_fma_f32 v[114:115], v[94:95], v[94:95], v[114:115]
    v_pk_add_f32 v[104:105], v[104:105], v[106:107]
    v_pk_fma_f32 v[116:117], v[98:99], v[98:99], v[116:117]
    v_pk_fma_f32 v[118:119], v[102:103], v[102:103], v[118:119]
    v_pk_add_f32 v[108:109], v[108:109], v[110:111]
    v_pk_add_f32 v[112:113], v[112:113], v[114:115]
    v_add_f32 v120, v104, v105
    v_pk_add_f32 v[116:117], v[116:117], v[118:119]
    v_add_f32 v121, v108, v109
    v_add_f32 v122, v112, v113
    v_add_f32 v123, v116, v117
    v_add_f32_dpp v120, v120, v120 quad_perm:[1,0,3,2] row_mask:0xf bank_mask:0xf
    v_add_f32_dpp v121, v121, v121 quad_perm:[1,0,3,2] row_mask:0xf bank_mask:0xf
    v_add_f32_dpp v122, v122, v122 quad_perm:[1,0,3,2] row_mask:0xf bank_mask:0xf
    v_add_f32_dpp v123, v123, v123 quad_perm:[1,0,3,2] row_mask:0xf bank_mask:0xf
    v_add_f32_dpp v120, v120, v120 quad_perm:[2,3,0,1] row_mask:0xf bank_mask:0xf
    v_add_f32_dpp v121, v121, v121 quad_perm:[2,3,0,1] row_mask:0xf bank_mask:0xf
    v_add_f32_dpp v122, v122, v122 quad_perm:[2,3,0,1] row_mask:0xf bank_mask:0xf
    v_add_f32_dpp v123, v123, v123 quad_perm:[2,3,0,1] row_mask:0xf bank_mask:0xf
    v_add_f32_dpp v120, v120, v120 row_half_mirror row_mask:0xf bank_mask:0xf
    v_add_f32_dpp v121, v121, v121 row_half_mirror row_mask:0xf bank_mask:0xf
    v_add_f32_dpp v122, v122, v122 row_half_mirror row_mask:0xf bank_mask:0xf
    v_add_f32_dpp v123, v123, v123 row_half_mirror row_mask:0xf bank_mask:0xf
    v_add_f32_dpp v120, v120, v120 row_mirror row_mask:0xf bank_mask:0xf
    v_add_f32_dpp v121, v121, v121 row_mirror row_mask:0xf bank_mask:0xf
    v_add_f32_dpp v122, v122, v122 row_mirror row_mask:0xf bank_mask:0xf
    v_add_f32_dpp v123, v123, v123 row_mirror row_mask:0xf bank_mask:0xf
    v_add_f32_dpp v120, v120, v120 row_bcast:15 row_mask:0xa bank_mask:0xf
    v_add_f32_dpp v121, v121, v121 row_bcast:15 row_mask:0xa bank_mask:0xf
    v_add_f32_dpp v122, v122, v122 row_bcast:15 row_mask:0xa bank_mask:0xf
    v_add_f32_dpp v123, v123, v123 row_bcast:15 row_mask:0xa bank_mask:0xf
    v_add_f32_dpp v120, v120, v120 row_bcast:31 row_mask:0xc bank_mask:0xf
    v_add_f32_dpp v121, v121, v121 row_bcast:31 row_mask:0xc bank_mask:0xf
    v_add_f32_dpp v122, v122, v122 row_bcast:31 row_mask:0xc bank_mask:0xf
    v_add_f32_dpp v123, v123, v123 row_bcast:31 row_mask:0xc bank_mask:0xf
    v_readlane_b32 s44, v120, 63
    v_readlane_b32 s45, v121, 63
    v_readlane_b32 s46, v122, 63
    v_readlane_b32 s47, v123, 63
    v_mul_f32 v88, s44, v124
    v_mul_f32 v90, s46, v124
    v_mul_f32 v89, s45, v124
    v_mul_f32 v91, s47, v124
    v_fma_f32 v90, -v88, v88, v90
    v_add_f32 v88, s40, v88
    v_fma_f32 v91, -v89, v89, v91
    v_add_f32 v89, s42, v89
    v_max_f32 v90, 0, v90
    v_max_f32 v91, 0, v91
    v_cvt_pk_bf16_f32 v102, v88, v89
    v_mov_b32 v94, v90
    v_mov_b32 v95, v91
    v_lshlrev_b32 v92, 16, v102
    v_and_b32 v93, 0xffff0000, v102
    v_cvt_pk_bf16_f32 v98, v94, v95
    v_lshlrev_b32 v94, 16, v98
    v_and_b32 v95, 0xffff0000, v98
    v_add_f32 v94, 0x3727c5ac, v94
    v_add_f32 v95, 0x3727c5ac, v95
    v_cvt_pk_bf16_f32 v98, v94, v95
    v_lshlrev_b32 v94, 16, v98
    v_and_b32 v95, 0xffff0000, v98
    v_sqrt_f32 v94, v94
    v_sqrt_f32 v95, v95
    s_nop 0
    v_cvt_pk_bf16_f32 v98, v94, v95
    v_lshlrev_b32 v94, 16, v98
    v_and_b32 v95, 0xffff0000, v98
    v_rcp_f32 v96, v94
    v_rcp_f32 v97, v95
    v_sub_f32 v88, v88, v92
    v_mul_f32 v90, v90, v96
    v_sub_f32 v89, v89, v93
    v_mul_f32 v91, v91, v97
    v_mul_f32 v90, v90, v96
    v_mul_f32 v88, v88, v96
    v_mul_f32 v91, v91, v97
    v_mul_f32 v89, v89, v97
    v_cvt_pk_bf16_f32 v102, v88, v89
    v_lshlrev_b32 v88, 16, v102
    v_and_b32 v89, 0xffff0000, v102
    v_fma_f32 v104, v92, v96, v88
    v_fma_f32 v105, v93, v97, v89
    v_cvt_pk_bf16_f32 v98, v90, v91
    v_lshlrev_b32 v90, 16, v98
    v_and_b32 v91, 0xffff0000, v98
    v_add_f32 v90, 0x3727c5ac, v90
    v_add_f32 v91, 0x3727c5ac, v91
    v_cvt_pk_bf16_f32 v98, v90, v91
    v_lshlrev_b32 v90, 16, v98
    v_and_b32 v91, 0xffff0000, v98
    v_sqrt_f32 v90, v90
    v_sqrt_f32 v91, v91
    s_nop 0
    v_cvt_pk_bf16_f32 v98, v90, v91
    v_lshlrev_b32 v90, 16, v98
    v_and_b32 v91, 0xffff0000, v98
    v_rcp_f32 v100, v90
    v_rcp_f32 v101, v91
    v_mul_f32 v96, v96, v100
    v_mul_f32_e64 v104, -v104, v100
    v_mul_f32 v97, v97, v101
    v_mul_f32_e64 v105, -v105, v101
    v_pk_fma_f32 v[72:73], v[72:73], v[96:97], v[104:105] op_sel:[0,0,0] op_sel_hi:[1,0,0]
    v_pk_fma_f32 v[80:81], v[80:81], v[96:97], v[104:105] op_sel:[0,1,1] op_sel_hi:[1,1,1]
    v_pk_fma_f32 v[74:75], v[74:75], v[96:97], v[104:105] op_sel:[0,0,0] op_sel_hi:[1,0,0]
    v_pk_fma_f32 v[82:83], v[82:83], v[96:97], v[104:105] op_sel:[0,1,1] op_sel_hi:[1,1,1]
    v_pk_fma_f32 v[76:77], v[76:77], v[96:97], v[104:105] op_sel:[0,0,0] op_sel_hi:[1,0,0]
    v_pk_fma_f32 v[84:85], v[84:85], v[96:97], v[104:105] op_sel:[0,1,1] op_sel_hi:[1,1,1]
    v_pk_fma_f32 v[78:79], v[78:79], v[96:97], v[104:105] op_sel:[0,0,0] op_sel_hi:[1,0,0]
    v_pk_fma_f32 v[86:87], v[86:87], v[96:97], v[104:105] op_sel:[0,1,1] op_sel_hi:[1,1,1]
    v_cvt_pk_bf16_f32 v64, v72, v73
    v_cvt_pk_bf16_f32 v68, v80, v81
    v_cvt_pk_bf16_f32 v65, v74, v75
    v_cvt_pk_bf16_f32 v69, v82, v83
    v_cvt_pk_bf16_f32 v66, v76, v77
    v_cvt_pk_bf16_f32 v70, v84, v85
    v_cvt_pk_bf16_f32 v67, v78, v79
    v_cvt_pk_bf16_f32 v71, v86, v87
    ds_write_b64 v62, v[64:65] offset:0
    ds_write_b64 v62, v[66:67] offset:512
    ds_write_b64 v62, v[68:69] offset:1088
    ds_write_b64 v62, v[70:71] offset:1600
    s_waitcnt lgkmcnt(0)
    s_barrier
    ds_read_b64_tr_b16 v[72:73], v63 offset:0
    ds_read_b64_tr_b16 v[74:75], v63 offset:4352
    ds_read_b64_tr_b16 v[76:77], v63 offset:128
    ds_read_b64_tr_b16 v[78:79], v63 offset:4480
    s_lshl_b32 s30, s12, 3
    s_add_u32 s30, s30, s13
    s_lshl_b32 s30, s30, 13
    s_lshl_b32 s31, s3, 11
    s_add_u32 s30, s30, s31
    v_lshlrev_b32 v4, 4, v1
    s_waitcnt lgkmcnt(2)
    buffer_store_dwordx4 v[72:75], v4, s[36:39], s30 offen offset:0 sc0 sc1
    s_waitcnt lgkmcnt(0)
    buffer_store_dwordx4 v[76:79], v4, s[36:39], s30 offen offset:1024 sc0 sc1
    s_waitcnt vmcnt(6)
    buffer_store_dwordx4 v[132:135], v147, s[52:55], s63 offen offset:0 sc0 sc1
    buffer_store_dwordx4 v[136:139], v147, s[52:55], s63 offen offset:1024 sc0 sc1
    buffer_store_dwordx4 v[140:143], v147, s[52:55], s63 offen offset:2048 sc0 sc1
    s_cmp_ge_u32 s2, 4
    s_cbranch_scc1 K3_NZ
    s_cmp_lg_u32 s3, 0
    s_cbranch_scc1 K3_NZ
    s_add_u32 s40, s4, 0x1f00000
    s_addc_u32 s41, s5, 0
    s_and_b32 s41, s41, 0xffff
    s_mov_b32 s42, 0x8000
    s_mov_b32 s43, 0x20000
    s_lshl_b32 s44, s2, 13
    v_lshlrev_b32 v4, 7, v1
    v_mov_b32 v5, 0
    buffer_store_dword v5, v4, s[40:43], s44 offen sc0 sc1
K3_NZ:
K3_END:
    s_endpgm

.globl sequential_preLN__spectral_gfnet__mixer_token_mlp__prompt_kernel
.p2align 8
.type sequential_preLN__spectral_gfnet__mixer_token_mlp__prompt_kernel,@function
sequential_preLN__spectral_gfnet__mixer_token_mlp__prompt_kernel:
    s_cmp_ge_u32 s2, 256
    s_cbranch_scc1 K5_END
    s_load_dwordx2 s[6:7], s[0:1], 40
    s_load_dwordx2 s[12:13], s[0:1], 80
    s_load_dwordx4 s[56:59], s[0:1], 48
    s_load_dwordx2 s[60:61], s[0:1], 64
    v_and_b32 v1, 63, v0
    v_lshrrev_b32 v2, 6, v0
    s_and_b32 s14, s2, 7
    s_lshr_b32 s15, s2, 3
    v_readfirstlane_b32 s3, v2
    s_cmp_ge_u32 s2, 232
    s_cbranch_scc1 P2_IDLE
    s_lshr_b32 s16, s14, 1
    s_mul_i32 s16, s16, 29
    s_add_u32 s16, s16, s15
    s_and_b32 s14, s14, 1
    s_lshl_b32 s14, s14, 2
    s_and_b32 s15, s16, 3
    s_add_u32 s14, s14, s15
    s_lshr_b32 s15, s16, 2
    v_lshrrev_b32 v2, 4, v1
    v_and_b32 v3, 15, v1
    v_lshlrev_b32 v4, 4, v1
    v_lshlrev_b32 v7, 13, v2
    v_lshl_add_u32 v7, v3, 4, v7
    v_lshrrev_b32 v10, 2, v3
    v_lshl_add_u32 v10, v2, 2, v10
    v_mul_u32_u24 v10, 96, v10
    v_and_b32 v11, 3, v1
    v_lshl_add_u32 v8, v11, 3, v10
    s_mul_i32 s17, s3, 20480
    v_add_u32 v8, s17, v8
    s_mul_i32 s18, s3, 49152
    s_mul_i32 s19, s15, 196608
    s_add_u32 s18, s18, s19
    s_lshl_b32 s19, s3, 19
    s_lshl_b32 s20, s14, 10
    s_add_u32 s19, s19, s20
    s_mul_i32 s21, s15, 96
    v_lshlrev_b32 v9, 3, v2
    s_waitcnt lgkmcnt(0)
    s_add_u32 s8, s12, 0x1100000
    s_addc_u32 s9, s13, 0
    s_and_b32 s9, s9, 0xffff
    s_mov_b32 s10, 0x570000
    s_mov_b32 s11, 0x20000
    s_add_u32 s24, s12, 0xc00000
    s_addc_u32 s25, s13, 0
    s_and_b32 s25, s25, 0xffff
    s_mov_b32 s26, 0x200000
    s_mov_b32 s27, 0x20000
    s_mov_b32 s28, s6
    s_and_b32 s29, s7, 0xffff
    s_mov_b32 s30, 0xac0
    s_mov_b32 s31, 0x20000
    s_add_u32 s32, s12, 0xf00000
    s_addc_u32 s33, s13, 0
    s_and_b32 s33, s33, 0xffff
    s_mov_b32 s34, 0x158000
    s_mov_b32 s35, 0x20000
    s_lshr_b32 s42, s15, 1
    s_and_b32 s42, s42, 1
    s_mul_i32 s42, s42, 4
    s_and_b32 s42, s42, 7
    s_add_u32 m0, s17, 0
    s_add_u32 s43, s42, 0
    s_and_b32 s43, s43, 7
    s_mul_i32 s22, s43, 6144
    s_lshl_b32 s23, s43, 16
    s_add_u32 s22, s22, s18
    s_add_u32 s23, s23, s19
    buffer_load_dwordx4 v4, s[8:11], s22 offen offset:0 lds
    buffer_load_dwordx4 v4, s[8:11], s22 offen offset:1024 lds
    buffer_load_dwordx4 v4, s[8:11], s22 offen offset:2048 lds
    buffer_load_dwordx4 v[88:91], v7, s[24:27], s23 offen offset:0
    buffer_load_dwordx4 v[92:95], v7, s[24:27], s23 offen offset:256
    buffer_load_dwordx4 v[96:99], v7, s[24:27], s23 offen offset:512
    buffer_load_dwordx4 v[100:103], v7, s[24:27], s23 offen offset:768
    s_add_u32 m0, s17, 3072
    s_add_u32 s43, s42, 0
    s_and_b32 s43, s43, 7
    s_mul_i32 s22, s43, 6144
    s_lshl_b32 s23, s43, 16
    s_add_u32 s22, s22, s18
    s_add_u32 s23, s23, s19
    s_add_u32 s22, s22, 3072
    s_add_u32 s23, s23, 32768
    buffer_load_dwordx4 v4, s[8:11], s22 offen offset:0 lds
    buffer_load_dwordx4 v4, s[8:11], s22 offen offset:1024 lds
    buffer_load_dwordx4 v4, s[8:11], s22 offen offset:2048 lds
    buffer_load_dwordx4 v[104:107], v7, s[24:27], s23 offen offset:0
    buffer_load_dwordx4 v[108:111], v7, s[24:27], s23 offen offset:256
    buffer_load_dwordx4 v[112:115], v7, s[24:27], s23 offen offset:512
    buffer_load_dwordx4 v[116:119], v7, s[24:27], s23 offen offset:768
    s_add_u32 m0, s17, 6144
    s_add_u32 s43, s42, 1
    s_and_b32 s43, s43, 7
    s_mul_i32 s22, s43, 6144
    s_lshl_b32 s23, s43, 16
    s_add_u32 s22, s22, s18
    s_add_u32 s23, s23, s19
    buffer_load_dwordx4 v4, s[8:11], s22 offen offset:0 lds
    buffer_load_dwordx4 v4, s[8:11], s22 offen offset:1024 lds
    buffer_load_dwordx4 v4, s[8:11], s22 offen offset:2048 lds
    buffer_load_dwordx4 v[120:123], v7, s[24:27], s23 offen offset:0
    buffer_load_dwordx4 v[124:127], v7, s[24:27], s23 offen offset:256
    buffer_load_dwordx4 v[128:131], v7, s[24:27], s23 offen offset:512
    buffer_load_dwordx4 v[132:135], v7, s[24:27], s23 offen offset:768
    s_add_u32 m0, s17, 9216
    s_add_u32 s43, s42, 1
    s_and_b32 s43, s43, 7
    s_mul_i32 s22, s43, 6144
    s_lshl_b32 s23, s43, 16
    s_add_u32 s22, s22, s18
    s_add_u32 s23, s23, s19
    s_add_u32 s22, s22, 3072
    s_add_u32 s23, s23, 32768
    buffer_load_dwordx4 v4, s[8:11], s22 offen offset:0 lds
    buffer_load_dwordx4 v4, s[8:11], s22 offen offset:1024 lds
    buffer_load_dwordx4 v4, s[8:11], s22 offen offset:2048 lds
    buffer_load_dwordx4 v[136:139], v7, s[24:27], s23 offen offset:0
    buffer_load_dwordx4 v[140:143], v7, s[24:27], s23 offen offset:256
    buffer_load_dwordx4 v[144:147], v7, s[24:27], s23 offen offset:512
    buffer_load_dwordx4 v[148:151], v7, s[24:27], s23 offen offset:768
    buffer_load_dwordx2 v[10:11], v9, s[28:31], s21 offen offset:0
    buffer_load_dwordx2 v[12:13], v9, s[28:31], s21 offen offset:32
    buffer_load_dwordx2 v[14:15], v9, s[28:31], s21 offen offset:64
    s_mov_b32 s48, s56
    s_and_b32 s49, s57, 0xffff
    s_mov_b32 s50, 0x560000
    s_mov_b32 s51, 0x20000
    s_lshr_b32 s47, s2, 3
    s_and_b32 s63, s47, 3
    s_mul_i32 s63, s63, 3
    s_lshr_b32 s47, s47, 2
    s_and_b32 s46, s47, 7
    s_mul_i32 s46, s46, 1
    s_add_u32 s63, s63, s46
    s_bfe_u32 s46, s2, 0x20001
    s_lshl_b32 s46, s46, 3
    s_add_u32 s46, s46, s47
    s_lshl_b32 s46, s46, 7
    s_mul_i32 s47, s3, 1441792
    s_add_u32 s46, s46, s47
    s_sub_u32 s47, s63, 11
    s_cmp_ge_u32 s63, 11
    s_cselect_b32 s63, s47, s63
    s_mul_i32 s62, s3, 20480
    v_lshrrev_b32 v249, 3, v1
    v_bfe_u32 v250, v249, 1, 2
    v_lshlrev_b32 v250, 1, v250
    v_and_b32 v251, 7, v1
    v_xor_b32 v250, v250, v251
    v_lshlrev_b32 v250, 4, v250
    v_lshl_add_u32 v248, v249, 12, v250
    v_add_u32 v249, 31744, v248
    v_add_u32 v250, 63488, v248
    v_add_u32 v251, 95232, v248
    v_bfe_u32 v253, v1, 2, 2
    v_bfe_u32 v254, v1, 4, 1
    v_lshl_add_u32 v253, v254, 2, v253
    v_lshrrev_b32 v254, 5, v1
    v_lshl_add_u32 v253, v254, 4, v253
    v_bfe_u32 v254, v253, 1, 2
    v_lshlrev_b32 v253, 7, v253
    v_lshl_add_u32 v253, v254, 5, v253
    v_and_b32 v254, 3, v1
    v_lshl_add_u32 v253, v254, 3, v253
    v_add_u32 v252, s62, v253
    v_xor_b32 v253, 32, v252
    v_xor_b32 v254, 64, v252
    v_xor_b32 v255, 96, v252
    s_waitcnt vmcnt(28)
    ds_read_b64_tr_b16 v[64:65], v8 offset:0
    ds_read_b64_tr_b16 v[66:67], v8 offset:1536
    ds_read_b64_tr_b16 v[68:69], v8 offset:32
    ds_read_b64_tr_b16 v[70:71], v8 offset:1568
    ds_read_b64_tr_b16 v[72:73], v8 offset:64
    ds_read_b64_tr_b16 v[74:75], v8 offset:1600
    s_waitcnt vmcnt(21)
    ds_read_b64_tr_b16 v[76:77], v8 offset:3072
    ds_read_b64_tr_b16 v[78:79], v8 offset:4608
    ds_read_b64_tr_b16 v[80:81], v8 offset:3104
    ds_read_b64_tr_b16 v[82:83], v8 offset:4640
    ds_read_b64_tr_b16 v[84:85], v8 offset:3136
    ds_read_b64_tr_b16 v[86:87], v8 offset:4672
    s_waitcnt lgkmcnt(6)
    v_mfma_f32_16x16x32_bf16 v[16:19], v[64:67], v[88:91], 0
    v_mfma_f32_16x16x32_bf16 v[20:23], v[64:67], v[92:95], 0
    v_mfma_f32_16x16x32_bf16 v[24:27], v[64:67], v[96:99], 0
    v_mfma_f32_16x16x32_bf16 v[28:31], v[64:67], v[100:103], 0
    v_mfma_f32_16x16x32_bf16 v[32:35], v[68:71], v[88:91], 0
    v_mfma_f32_16x16x32_bf16 v[36:39], v[68:71], v[92:95], 0
    v_mfma_f32_16x16x32_bf16 v[40:43], v[68:71], v[96:99], 0
    v_mfma_f32_16x16x32_bf16 v[44:47], v[68:71], v[100:103], 0
    v_mfma_f32_16x16x32_bf16 v[48:51], v[72:75], v[88:91], 0
    v_mfma_f32_16x16x32_bf16 v[52:55], v[72:75], v[92:95], 0
    v_mfma_f32_16x16x32_bf16 v[56:59], v[72:75], v[96:99], 0
    v_mfma_f32_16x16x32_bf16 v[60:63], v[72:75], v[100:103], 0
    s_add_u32 m0, s17, 0
    s_add_u32 s43, s42, 2
    s_and_b32 s43, s43, 7
    s_mul_i32 s22, s43, 6144
    s_lshl_b32 s23, s43, 16
    s_add_u32 s22, s22, s18
    s_add_u32 s23, s23, s19
    buffer_load_dwordx4 v4, s[8:11], s22 offen offset:0 lds
    buffer_load_dwordx4 v4, s[8:11], s22 offen offset:1024 lds
    buffer_load_dwordx4 v4, s[8:11], s22 offen offset:2048 lds
    buffer_load_dwordx4 v[88:91], v7, s[24:27], s23 offen offset:0
    buffer_load_dwordx4 v[92:95], v7, s[24:27], s23 offen offset:256
    buffer_load_dwordx4 v[96:99], v7, s[24:27], s23 offen offset:512
    buffer_load_dwordx4 v[100:103], v7, s[24:27], s23 offen offset:768
    s_waitcnt vmcnt(21)
    ds_read_b64_tr_b16 v[64:65], v8 offset:6144
    ds_read_b64_tr_b16 v[66:67], v8 offset:7680
    ds_read_b64_tr_b16 v[68:69], v8 offset:6176
    ds_read_b64_tr_b16 v[70:71], v8 offset:7712
    ds_read_b64_tr_b16 v[72:73], v8 offset:6208
    ds_read_b64_tr_b16 v[74:75], v8 offset:7744
    s_waitcnt lgkmcnt(6)
    v_mfma_f32_16x16x32_bf16 v[16:19], v[76:79], v[104:107], v[16:19]
    v_mfma_f32_16x16x32_bf16 v[20:23], v[76:79], v[108:111], v[20:23]
    v_mfma_f32_16x16x32_bf16 v[24:27], v[76:79], v[112:115], v[24:27]
    v_mfma_f32_16x16x32_bf16 v[28:31], v[76:79], v[116:119], v[28:31]
    v_mfma_f32_16x16x32_bf16 v[32:35], v[80:83], v[104:107], v[32:35]
    v_mfma_f32_16x16x32_bf16 v[36:39], v[80:83], v[108:111], v[36:39]
    v_mfma_f32_16x16x32_bf16 v[40:43], v[80:83], v[112:115], v[40:43]
    v_mfma_f32_16x16x32_bf16 v[44:47], v[80:83], v[116:119], v[44:47]
    v_mfma_f32_16x16x32_bf16 v[48:51], v[84:87], v[104:107], v[48:51]
    v_mfma_f32_16x16x32_bf16 v[52:55], v[84:87], v[108:111], v[52:55]
    v_mfma_f32_16x16x32_bf16 v[56:59], v[84:87], v[112:115], v[56:59]
    v_mfma_f32_16x16x32_bf16 v[60:63], v[84:87], v[116:119], v[60:63]
    s_add_u32 m0, s17, 3072
    s_add_u32 s43, s42, 2
    s_and_b32 s43, s43, 7
    s_mul_i32 s22, s43, 6144
    s_lshl_b32 s23, s43, 16
    s_add_u32 s22, s22, s18
    s_add_u32 s23, s23, s19
    s_add_u32 s22, s22, 3072
    s_add_u32 s23, s23, 32768
    buffer_load_dwordx4 v4, s[8:11], s22 offen offset:0 lds
    buffer_load_dwordx4 v4, s[8:11], s22 offen offset:1024 lds
    buffer_load_dwordx4 v4, s[8:11], s22 offen offset:2048 lds
    buffer_load_dwordx4 v[104:107], v7, s[24:27], s23 offen offset:0
    buffer_load_dwordx4 v[108:111], v7, s[24:27], s23 offen offset:256
    buffer_load_dwordx4 v[112:115], v7, s[24:27], s23 offen offset:512
    buffer_load_dwordx4 v[116:119], v7, s[24:27], s23 offen offset:768
    s_waitcnt vmcnt(21)
    ds_read_b64_tr_b16 v[76:77], v8 offset:9216
    ds_read_b64_tr_b16 v[78:79], v8 offset:10752
    ds_read_b64_tr_b16 v[80:81], v8 offset:9248
    ds_read_b64_tr_b16 v[82:83], v8 offset:10784
    ds_read_b64_tr_b16 v[84:85], v8 offset:9280
    ds_read_b64_tr_b16 v[86:87], v8 offset:10816
    s_waitcnt lgkmcnt(6)
    v_mfma_f32_16x16x32_bf16 v[16:19], v[64:67], v[120:123], v[16:19]
    v_mfma_f32_16x16x32_bf16 v[20:23], v[64:67], v[124:127], v[20:23]
    v_mfma_f32_16x16x32_bf16 v[24:27], v[64:67], v[128:131], v[24:27]
    v_mfma_f32_16x16x32_bf16 v[28:31], v[64:67], v[132:135], v[28:31]
    v_mfma_f32_16x16x32_bf16 v[32:35], v[68:71], v[120:123], v[32:35]
    v_mfma_f32_16x16x32_bf16 v[36:39], v[68:71], v[124:127], v[36:39]
    v_mfma_f32_16x16x32_bf16 v[40:43], v[68:71], v[128:131], v[40:43]
    v_mfma_f32_16x16x32_bf16 v[44:47], v[68:71], v[132:135], v[44:47]
    v_mfma_f32_16x16x32_bf16 v[48:51], v[72:75], v[120:123], v[48:51]
    v_mfma_f32_16x16x32_bf16 v[52:55], v[72:75], v[124:127], v[52:55]
    v_mfma_f32_16x16x32_bf16 v[56:59], v[72:75], v[128:131], v[56:59]
    v_mfma_f32_16x16x32_bf16 v[60:63], v[72:75], v[132:135], v[60:63]
    s_add_u32 m0, s17, 6144
    s_add_u32 s43, s42, 3
    s_and_b32 s43, s43, 7
    s_mul_i32 s22, s43, 6144
    s_lshl_b32 s23, s43, 16
    s_add_u32 s22, s22, s18
    s_add_u32 s23, s23, s19
    buffer_load_dwordx4 v4, s[8:11], s22 offen offset:0 lds
    buffer_load_dwordx4 v4, s[8:11], s22 offen offset:1024 lds
    buffer_load_dwordx4 v4, s[8:11], s22 offen offset:2048 lds
    buffer_load_dwordx4 v[120:123], v7, s[24:27], s23 offen offset:0
    buffer_load_dwordx4 v[124:127], v7, s[24:27], s23 offen offset:256
    buffer_load_dwordx4 v[128:131], v7, s[24:27], s23 offen offset:512
    buffer_load_dwordx4 v[132:135], v7, s[24:27], s23 offen offset:768
    s_waitcnt vmcnt(18)
    ds_read_b64_tr_b16 v[64:65], v8 offset:0
    ds_read_b64_tr_b16 v[66:67], v8 offset:1536
    ds_read_b64_tr_b16 v[68:69], v8 offset:32
    ds_read_b64_tr_b16 v[70:71], v8 offset:1568
    ds_read_b64_tr_b16 v[72:73], v8 offset:64
    ds_read_b64_tr_b16 v[74:75], v8 offset:1600
    s_waitcnt lgkmcnt(6)
    v_mfma_f32_16x16x32_bf16 v[16:19], v[76:79], v[136:139], v[16:19]
    v_mfma_f32_16x16x32_bf16 v[20:23], v[76:79], v[140:143], v[20:23]
    v_mfma_f32_16x16x32_bf16 v[24:27], v[76:79], v[144:147], v[24:27]
    v_mfma_f32_16x16x32_bf16 v[28:31], v[76:79], v[148:151], v[28:31]
    v_mfma_f32_16x16x32_bf16 v[32:35], v[80:83], v[136:139], v[32:35]
    v_mfma_f32_16x16x32_bf16 v[36:39], v[80:83], v[140:143], v[36:39]
    v_mfma_f32_16x16x32_bf16 v[40:43], v[80:83], v[144:147], v[40:43]
    v_mfma_f32_16x16x32_bf16 v[44:47], v[80:83], v[148:151], v[44:47]
    v_mfma_f32_16x16x32_bf16 v[48:51], v[84:87], v[136:139], v[48:51]
    v_mfma_f32_16x16x32_bf16 v[52:55], v[84:87], v[140:143], v[52:55]
    v_mfma_f32_16x16x32_bf16 v[56:59], v[84:87], v[144:147], v[56:59]
    v_mfma_f32_16x16x32_bf16 v[60:63], v[84:87], v[148:151], v[60:63]
    s_add_u32 m0, s17, 9216
    s_add_u32 s43, s42, 3
    s_and_b32 s43, s43, 7
    s_mul_i32 s22, s43, 6144
    s_lshl_b32 s23, s43, 16
    s_add_u32 s22, s22, s18
    s_add_u32 s23, s23, s19
    s_add_u32 s22, s22, 3072
    s_add_u32 s23, s23, 32768
    buffer_load_dwordx4 v4, s[8:11], s22 offen offset:0 lds
    buffer_load_dwordx4 v4, s[8:11], s22 offen offset:1024 lds
    buffer_load_dwordx4 v4, s[8:11], s22 offen offset:2048 lds
    buffer_load_dwordx4 v[136:139], v7, s[24:27], s23 offen offset:0
    buffer_load_dwordx4 v[140:143], v7, s[24:27], s23 offen offset:256
    buffer_load_dwordx4 v[144:147], v7, s[24:27], s23 offen offset:512
    buffer_load_dwordx4 v[148:151], v7, s[24:27], s23 offen offset:768
    s_waitcnt vmcnt(18)
    ds_read_b64_tr_b16 v[76:77], v8 offset:3072
    ds_read_b64_tr_b16 v[78:79], v8 offset:4608
    ds_read_b64_tr_b16 v[80:81], v8 offset:3104
    ds_read_b64_tr_b16 v[82:83], v8 offset:4640
    ds_read_b64_tr_b16 v[84:85], v8 offset:3136
    ds_read_b64_tr_b16 v[86:87], v8 offset:4672
    s_waitcnt lgkmcnt(6)
    v_mfma_f32_16x16x32_bf16 v[16:19], v[64:67], v[88:91], v[16:19]
    v_mfma_f32_16x16x32_bf16 v[20:23], v[64:67], v[92:95], v[20:23]
    v_mfma_f32_16x16x32_bf16 v[24:27], v[64:67], v[96:99], v[24:27]
    v_mfma_f32_16x16x32_bf16 v[28:31], v[64:67], v[100:103], v[28:31]
    v_mfma_f32_16x16x32_bf16 v[32:35], v[68:71], v[88:91], v[32:35]
    v_mfma_f32_16x16x32_bf16 v[36:39], v[68:71], v[92:95], v[36:39]
    v_mfma_f32_16x16x32_bf16 v[40:43], v[68:71], v[96:99], v[40:43]
    v_mfma_f32_16x16x32_bf16 v[44:47], v[68:71], v[100:103], v[44:47]
    v_mfma_f32_16x16x32_bf16 v[48:51], v[72:75], v[88:91], v[48:51]
    v_mfma_f32_16x16x32_bf16 v[52:55], v[72:75], v[92:95], v[52:55]
    v_mfma_f32_16x16x32_bf16 v[56:59], v[72:75], v[96:99], v[56:59]
    v_mfma_f32_16x16x32_bf16 v[60:63], v[72:75], v[100:103], v[60:63]
    s_add_u32 m0, s17, 0
    s_add_u32 s43, s42, 4
    s_and_b32 s43, s43, 7
    s_mul_i32 s22, s43, 6144
    s_lshl_b32 s23, s43, 16
    s_add_u32 s22, s22, s18
    s_add_u32 s23, s23, s19
    buffer_load_dwordx4 v4, s[8:11], s22 offen offset:0 lds
    buffer_load_dwordx4 v4, s[8:11], s22 offen offset:1024 lds
    buffer_load_dwordx4 v4, s[8:11], s22 offen offset:2048 lds
    buffer_load_dwordx4 v[88:91], v7, s[24:27], s23 offen offset:0
    buffer_load_dwordx4 v[92:95], v7, s[24:27], s23 offen offset:256
    buffer_load_dwordx4 v[96:99], v7, s[24:27], s23 offen offset:512
    buffer_load_dwordx4 v[100:103], v7, s[24:27], s23 offen offset:768
    s_waitcnt vmcnt(18)
    ds_read_b64_tr_b16 v[64:65], v8 offset:6144
    ds_read_b64_tr_b16 v[66:67], v8 offset:7680
    ds_read_b64_tr_b16 v[68:69], v8 offset:6176
    ds_read_b64_tr_b16 v[70:71], v8 offset:7712
    ds_read_b64_tr_b16 v[72:73], v8 offset:6208
    ds_read_b64_tr_b16 v[74:75], v8 offset:7744
    s_waitcnt lgkmcnt(6)
    v_mfma_f32_16x16x32_bf16 v[16:19], v[76:79], v[104:107], v[16:19]
    v_mfma_f32_16x16x32_bf16 v[20:23], v[76:79], v[108:111], v[20:23]
    v_mfma_f32_16x16x32_bf16 v[24:27], v[76:79], v[112:115], v[24:27]
    v_mfma_f32_16x16x32_bf16 v[28:31], v[76:79], v[116:119], v[28:31]
    v_mfma_f32_16x16x32_bf16 v[32:35], v[80:83], v[104:107], v[32:35]
    v_mfma_f32_16x16x32_bf16 v[36:39], v[80:83], v[108:111], v[36:39]
    v_mfma_f32_16x16x32_bf16 v[40:43], v[80:83], v[112:115], v[40:43]
    v_mfma_f32_16x16x32_bf16 v[44:47], v[80:83], v[116:119], v[44:47]
    v_mfma_f32_16x16x32_bf16 v[48:51], v[84:87], v[104:107], v[48:51]
    v_mfma_f32_16x16x32_bf16 v[52:55], v[84:87], v[108:111], v[52:55]
    v_mfma_f32_16x16x32_bf16 v[56:59], v[84:87], v[112:115], v[56:59]
    v_mfma_f32_16x16x32_bf16 v[60:63], v[84:87], v[116:119], v[60:63]
    s_add_u32 m0, s17, 3072
    s_add_u32 s43, s42, 4
    s_and_b32 s43, s43, 7
    s_mul_i32 s22, s43, 6144
    s_lshl_b32 s23, s43, 16
    s_add_u32 s22, s22, s18
    s_add_u32 s23, s23, s19
    s_add_u32 s22, s22, 3072
    s_add_u32 s23, s23, 32768
    buffer_load_dwordx4 v4, s[8:11], s22 offen offset:0 lds
    buffer_load_dwordx4 v4, s[8:11], s22 offen offset:1024 lds
    buffer_load_dwordx4 v4, s[8:11], s22 offen offset:2048 lds
    buffer_load_dwordx4 v[104:107], v7, s[24:27], s23 offen offset:0
    buffer_load_dwordx4 v[108:111], v7, s[24:27], s23 offen offset:256
    buffer_load_dwordx4 v[112:115], v7, s[24:27], s23 offen offset:512
    buffer_load_dwordx4 v[116:119], v7, s[24:27], s23 offen offset:768
    s_waitcnt vmcnt(18)
    ds_read_b64_tr_b16 v[76:77], v8 offset:9216
    ds_read_b64_tr_b16 v[78:79], v8 offset:10752
    ds_read_b64_tr_b16 v[80:81], v8 offset:9248
    ds_read_b64_tr_b16 v[82:83], v8 offset:10784
    ds_read_b64_tr_b16 v[84:85], v8 offset:9280
    ds_read_b64_tr_b16 v[86:87], v8 offset:10816
    s_waitcnt lgkmcnt(6)
    v_mfma_f32_16x16x32_bf16 v[16:19], v[64:67], v[120:123], v[16:19]
    v_mfma_f32_16x16x32_bf16 v[20:23], v[64:67], v[124:127], v[20:23]
    v_mfma_f32_16x16x32_bf16 v[24:27], v[64:67], v[128:131], v[24:27]
    v_mfma_f32_16x16x32_bf16 v[28:31], v[64:67], v[132:135], v[28:31]
    v_mfma_f32_16x16x32_bf16 v[32:35], v[68:71], v[120:123], v[32:35]
    v_mfma_f32_16x16x32_bf16 v[36:39], v[68:71], v[124:127], v[36:39]
    v_mfma_f32_16x16x32_bf16 v[40:43], v[68:71], v[128:131], v[40:43]
    v_mfma_f32_16x16x32_bf16 v[44:47], v[68:71], v[132:135], v[44:47]
    v_mfma_f32_16x16x32_bf16 v[48:51], v[72:75], v[120:123], v[48:51]
    v_mfma_f32_16x16x32_bf16 v[52:55], v[72:75], v[124:127], v[52:55]
    v_mfma_f32_16x16x32_bf16 v[56:59], v[72:75], v[128:131], v[56:59]
    v_mfma_f32_16x16x32_bf16 v[60:63], v[72:75], v[132:135], v[60:63]
    s_add_u32 m0, s17, 6144
    s_add_u32 s43, s42, 5
    s_and_b32 s43, s43, 7
    s_mul_i32 s22, s43, 6144
    s_lshl_b32 s23, s43, 16
    s_add_u32 s22, s22, s18
    s_add_u32 s23, s23, s19
    buffer_load_dwordx4 v4, s[8:11], s22 offen offset:0 lds
    buffer_load_dwordx4 v4, s[8:11], s22 offen offset:1024 lds
    buffer_load_dwordx4 v4, s[8:11], s22 offen offset:2048 lds
    buffer_load_dwordx4 v[120:123], v7, s[24:27], s23 offen offset:0
    buffer_load_dwordx4 v[124:127], v7, s[24:27], s23 offen offset:256
    buffer_load_dwordx4 v[128:131], v7, s[24:27], s23 offen offset:512
    buffer_load_dwordx4 v[132:135], v7, s[24:27], s23 offen offset:768
    s_waitcnt vmcnt(18)
    ds_read_b64_tr_b16 v[64:65], v8 offset:0
    ds_read_b64_tr_b16 v[66:67], v8 offset:1536
    ds_read_b64_tr_b16 v[68:69], v8 offset:32
    ds_read_b64_tr_b16 v[70:71], v8 offset:1568
    ds_read_b64_tr_b16 v[72:73], v8 offset:64
    ds_read_b64_tr_b16 v[74:75], v8 offset:1600
    s_waitcnt lgkmcnt(6)
    v_mfma_f32_16x16x32_bf16 v[16:19], v[76:79], v[136:139], v[16:19]
    v_mfma_f32_16x16x32_bf16 v[20:23], v[76:79], v[140:143], v[20:23]
    v_mfma_f32_16x16x32_bf16 v[24:27], v[76:79], v[144:147], v[24:27]
    v_mfma_f32_16x16x32_bf16 v[28:31], v[76:79], v[148:151], v[28:31]
    v_mfma_f32_16x16x32_bf16 v[32:35], v[80:83], v[136:139], v[32:35]
    v_mfma_f32_16x16x32_bf16 v[36:39], v[80:83], v[140:143], v[36:39]
    v_mfma_f32_16x16x32_bf16 v[40:43], v[80:83], v[144:147], v[40:43]
    v_mfma_f32_16x16x32_bf16 v[44:47], v[80:83], v[148:151], v[44:47]
    v_mfma_f32_16x16x32_bf16 v[48:51], v[84:87], v[136:139], v[48:51]
    v_mfma_f32_16x16x32_bf16 v[52:55], v[84:87], v[140:143], v[52:55]
    v_mfma_f32_16x16x32_bf16 v[56:59], v[84:87], v[144:147], v[56:59]
    v_mfma_f32_16x16x32_bf16 v[60:63], v[84:87], v[148:151], v[60:63]
    s_add_u32 m0, s17, 9216
    s_add_u32 s43, s42, 5
    s_and_b32 s43, s43, 7
    s_mul_i32 s22, s43, 6144
    s_lshl_b32 s23, s43, 16
    s_add_u32 s22, s22, s18
    s_add_u32 s23, s23, s19
    s_add_u32 s22, s22, 3072
    s_add_u32 s23, s23, 32768
    buffer_load_dwordx4 v4, s[8:11], s22 offen offset:0 lds
    buffer_load_dwordx4 v4, s[8:11], s22 offen offset:1024 lds
    buffer_load_dwordx4 v4, s[8:11], s22 offen offset:2048 lds
    buffer_load_dwordx4 v[136:139], v7, s[24:27], s23 offen offset:0
    buffer_load_dwordx4 v[140:143], v7, s[24:27], s23 offen offset:256
    buffer_load_dwordx4 v[144:147], v7, s[24:27], s23 offen offset:512
    buffer_load_dwordx4 v[148:151], v7, s[24:27], s23 offen offset:768
    s_waitcnt vmcnt(18)
    ds_read_b64_tr_b16 v[76:77], v8 offset:3072
    ds_read_b64_tr_b16 v[78:79], v8 offset:4608
    ds_read_b64_tr_b16 v[80:81], v8 offset:3104
    ds_read_b64_tr_b16 v[82:83], v8 offset:4640
    ds_read_b64_tr_b16 v[84:85], v8 offset:3136
    ds_read_b64_tr_b16 v[86:87], v8 offset:4672
    s_waitcnt lgkmcnt(6)
    v_mfma_f32_16x16x32_bf16 v[16:19], v[64:67], v[88:91], v[16:19]
    v_mfma_f32_16x16x32_bf16 v[20:23], v[64:67], v[92:95], v[20:23]
    v_mfma_f32_16x16x32_bf16 v[24:27], v[64:67], v[96:99], v[24:27]
    v_mfma_f32_16x16x32_bf16 v[28:31], v[64:67], v[100:103], v[28:31]
    v_mfma_f32_16x16x32_bf16 v[32:35], v[68:71], v[88:91], v[32:35]
    v_mfma_f32_16x16x32_bf16 v[36:39], v[68:71], v[92:95], v[36:39]
    v_mfma_f32_16x16x32_bf16 v[40:43], v[68:71], v[96:99], v[40:43]
    v_mfma_f32_16x16x32_bf16 v[44:47], v[68:71], v[100:103], v[44:47]
    v_mfma_f32_16x16x32_bf16 v[48:51], v[72:75], v[88:91], v[48:51]
    v_mfma_f32_16x16x32_bf16 v[52:55], v[72:75], v[92:95], v[52:55]
    v_mfma_f32_16x16x32_bf16 v[56:59], v[72:75], v[96:99], v[56:59]
    v_mfma_f32_16x16x32_bf16 v[60:63], v[72:75], v[100:103], v[60:63]
    s_add_u32 m0, s17, 0
    s_add_u32 s43, s42, 6
    s_and_b32 s43, s43, 7
    s_mul_i32 s22, s43, 6144
    s_lshl_b32 s23, s43, 16
    s_add_u32 s22, s22, s18
    s_add_u32 s23, s23, s19
    buffer_load_dwordx4 v4, s[8:11], s22 offen offset:0 lds
    buffer_load_dwordx4 v4, s[8:11], s22 offen offset:1024 lds
    buffer_load_dwordx4 v4, s[8:11], s22 offen offset:2048 lds
    buffer_load_dwordx4 v[88:91], v7, s[24:27], s23 offen offset:0
    buffer_load_dwordx4 v[92:95], v7, s[24:27], s23 offen offset:256
    buffer_load_dwordx4 v[96:99], v7, s[24:27], s23 offen offset:512
    buffer_load_dwordx4 v[100:103], v7, s[24:27], s23 offen offset:768
    s_waitcnt vmcnt(18)
    ds_read_b64_tr_b16 v[64:65], v8 offset:6144
    ds_read_b64_tr_b16 v[66:67], v8 offset:7680
    ds_read_b64_tr_b16 v[68:69], v8 offset:6176
    ds_read_b64_tr_b16 v[70:71], v8 offset:7712
    ds_read_b64_tr_b16 v[72:73], v8 offset:6208
    ds_read_b64_tr_b16 v[74:75], v8 offset:7744
    s_waitcnt lgkmcnt(6)
    v_mfma_f32_16x16x32_bf16 v[16:19], v[76:79], v[104:107], v[16:19]
    v_mfma_f32_16x16x32_bf16 v[20:23], v[76:79], v[108:111], v[20:23]
    v_mfma_f32_16x16x32_bf16 v[24:27], v[76:79], v[112:115], v[24:27]
    v_mfma_f32_16x16x32_bf16 v[28:31], v[76:79], v[116:119], v[28:31]
    v_mfma_f32_16x16x32_bf16 v[32:35], v[80:83], v[104:107], v[32:35]
    v_mfma_f32_16x16x32_bf16 v[36:39], v[80:83], v[108:111], v[36:39]
    v_mfma_f32_16x16x32_bf16 v[40:43], v[80:83], v[112:115], v[40:43]
    v_mfma_f32_16x16x32_bf16 v[44:47], v[80:83], v[116:119], v[44:47]
    v_mfma_f32_16x16x32_bf16 v[48:51], v[84:87], v[104:107], v[48:51]
    v_mfma_f32_16x16x32_bf16 v[52:55], v[84:87], v[108:111], v[52:55]
    v_mfma_f32_16x16x32_bf16 v[56:59], v[84:87], v[112:115], v[56:59]
    v_mfma_f32_16x16x32_bf16 v[60:63], v[84:87], v[116:119], v[60:63]
    s_add_u32 m0, s17, 3072
    s_add_u32 s43, s42, 6
    s_and_b32 s43, s43, 7
    s_mul_i32 s22, s43, 6144
    s_lshl_b32 s23, s43, 16
    s_add_u32 s22, s22, s18
    s_add_u32 s23, s23, s19
    s_add_u32 s22, s22, 3072
    s_add_u32 s23, s23, 32768
    buffer_load_dwordx4 v4, s[8:11], s22 offen offset:0 lds
    buffer_load_dwordx4 v4, s[8:11], s22 offen offset:1024 lds
    buffer_load_dwordx4 v4, s[8:11], s22 offen offset:2048 lds
    buffer_load_dwordx4 v[104:107], v7, s[24:27], s23 offen offset:0
    buffer_load_dwordx4 v[108:111], v7, s[24:27], s23 offen offset:256
    buffer_load_dwordx4 v[112:115], v7, s[24:27], s23 offen offset:512
    buffer_load_dwordx4 v[116:119], v7, s[24:27], s23 offen offset:768
    s_waitcnt vmcnt(18)
    ds_read_b64_tr_b16 v[76:77], v8 offset:9216
    ds_read_b64_tr_b16 v[78:79], v8 offset:10752
    ds_read_b64_tr_b16 v[80:81], v8 offset:9248
    ds_read_b64_tr_b16 v[82:83], v8 offset:10784
    ds_read_b64_tr_b16 v[84:85], v8 offset:9280
    ds_read_b64_tr_b16 v[86:87], v8 offset:10816
    s_waitcnt lgkmcnt(6)
    v_mfma_f32_16x16x32_bf16 v[16:19], v[64:67], v[120:123], v[16:19]
    v_mfma_f32_16x16x32_bf16 v[20:23], v[64:67], v[124:127], v[20:23]
    v_mfma_f32_16x16x32_bf16 v[24:27], v[64:67], v[128:131], v[24:27]
    v_mfma_f32_16x16x32_bf16 v[28:31], v[64:67], v[132:135], v[28:31]
    v_mfma_f32_16x16x32_bf16 v[32:35], v[68:71], v[120:123], v[32:35]
    v_mfma_f32_16x16x32_bf16 v[36:39], v[68:71], v[124:127], v[36:39]
    v_mfma_f32_16x16x32_bf16 v[40:43], v[68:71], v[128:131], v[40:43]
    v_mfma_f32_16x16x32_bf16 v[44:47], v[68:71], v[132:135], v[44:47]
    v_mfma_f32_16x16x32_bf16 v[48:51], v[72:75], v[120:123], v[48:51]
    v_mfma_f32_16x16x32_bf16 v[52:55], v[72:75], v[124:127], v[52:55]
    v_mfma_f32_16x16x32_bf16 v[56:59], v[72:75], v[128:131], v[56:59]
    v_mfma_f32_16x16x32_bf16 v[60:63], v[72:75], v[132:135], v[60:63]
    s_add_u32 m0, s17, 6144
    s_add_u32 s43, s42, 7
    s_and_b32 s43, s43, 7
    s_mul_i32 s22, s43, 6144
    s_lshl_b32 s23, s43, 16
    s_add_u32 s22, s22, s18
    s_add_u32 s23, s23, s19
    buffer_load_dwordx4 v4, s[8:11], s22 offen offset:0 lds
    buffer_load_dwordx4 v4, s[8:11], s22 offen offset:1024 lds
    buffer_load_dwordx4 v4, s[8:11], s22 offen offset:2048 lds
    buffer_load_dwordx4 v[120:123], v7, s[24:27], s23 offen offset:0
    buffer_load_dwordx4 v[124:127], v7, s[24:27], s23 offen offset:256
    buffer_load_dwordx4 v[128:131], v7, s[24:27], s23 offen offset:512
    buffer_load_dwordx4 v[132:135], v7, s[24:27], s23 offen offset:768
    s_waitcnt vmcnt(18)
    ds_read_b64_tr_b16 v[64:65], v8 offset:0
    ds_read_b64_tr_b16 v[66:67], v8 offset:1536
    ds_read_b64_tr_b16 v[68:69], v8 offset:32
    ds_read_b64_tr_b16 v[70:71], v8 offset:1568
    ds_read_b64_tr_b16 v[72:73], v8 offset:64
    ds_read_b64_tr_b16 v[74:75], v8 offset:1600
    s_waitcnt lgkmcnt(6)
    v_mfma_f32_16x16x32_bf16 v[16:19], v[76:79], v[136:139], v[16:19]
    v_mfma_f32_16x16x32_bf16 v[20:23], v[76:79], v[140:143], v[20:23]
    v_mfma_f32_16x16x32_bf16 v[24:27], v[76:79], v[144:147], v[24:27]
    v_mfma_f32_16x16x32_bf16 v[28:31], v[76:79], v[148:151], v[28:31]
    v_mfma_f32_16x16x32_bf16 v[32:35], v[80:83], v[136:139], v[32:35]
    v_mfma_f32_16x16x32_bf16 v[36:39], v[80:83], v[140:143], v[36:39]
    v_mfma_f32_16x16x32_bf16 v[40:43], v[80:83], v[144:147], v[40:43]
    v_mfma_f32_16x16x32_bf16 v[44:47], v[80:83], v[148:151], v[44:47]
    v_mfma_f32_16x16x32_bf16 v[48:51], v[84:87], v[136:139], v[48:51]
    v_mfma_f32_16x16x32_bf16 v[52:55], v[84:87], v[140:143], v[52:55]
    v_mfma_f32_16x16x32_bf16 v[56:59], v[84:87], v[144:147], v[56:59]
    v_mfma_f32_16x16x32_bf16 v[60:63], v[84:87], v[148:151], v[60:63]
    s_add_u32 m0, s17, 9216
    s_add_u32 s43, s42, 7
    s_and_b32 s43, s43, 7
    s_mul_i32 s22, s43, 6144
    s_lshl_b32 s23, s43, 16
    s_add_u32 s22, s22, s18
    s_add_u32 s23, s23, s19
    s_add_u32 s22, s22, 3072
    s_add_u32 s23, s23, 32768
    buffer_load_dwordx4 v4, s[8:11], s22 offen offset:0 lds
    buffer_load_dwordx4 v4, s[8:11], s22 offen offset:1024 lds
    buffer_load_dwordx4 v4, s[8:11], s22 offen offset:2048 lds
    buffer_load_dwordx4 v[136:139], v7, s[24:27], s23 offen offset:0
    buffer_load_dwordx4 v[140:143], v7, s[24:27], s23 offen offset:256
    buffer_load_dwordx4 v[144:147], v7, s[24:27], s23 offen offset:512
    buffer_load_dwordx4 v[148:151], v7, s[24:27], s23 offen offset:768
    s_waitcnt vmcnt(18)
    ds_read_b64_tr_b16 v[76:77], v8 offset:3072
    ds_read_b64_tr_b16 v[78:79], v8 offset:4608
    ds_read_b64_tr_b16 v[80:81], v8 offset:3104
    ds_read_b64_tr_b16 v[82:83], v8 offset:4640
    ds_read_b64_tr_b16 v[84:85], v8 offset:3136
    ds_read_b64_tr_b16 v[86:87], v8 offset:4672
    s_waitcnt lgkmcnt(6)
    v_mfma_f32_16x16x32_bf16 v[16:19], v[64:67], v[88:91], v[16:19]
    v_mfma_f32_16x16x32_bf16 v[20:23], v[64:67], v[92:95], v[20:23]
    v_mfma_f32_16x16x32_bf16 v[24:27], v[64:67], v[96:99], v[24:27]
    v_mfma_f32_16x16x32_bf16 v[28:31], v[64:67], v[100:103], v[28:31]
    v_mfma_f32_16x16x32_bf16 v[32:35], v[68:71], v[88:91], v[32:35]
    v_mfma_f32_16x16x32_bf16 v[36:39], v[68:71], v[92:95], v[36:39]
    v_mfma_f32_16x16x32_bf16 v[40:43], v[68:71], v[96:99], v[40:43]
    v_mfma_f32_16x16x32_bf16 v[44:47], v[68:71], v[100:103], v[44:47]
    v_mfma_f32_16x16x32_bf16 v[48:51], v[72:75], v[88:91], v[48:51]
    v_mfma_f32_16x16x32_bf16 v[52:55], v[72:75], v[92:95], v[52:55]
    v_mfma_f32_16x16x32_bf16 v[56:59], v[72:75], v[96:99], v[56:59]
    v_mfma_f32_16x16x32_bf16 v[60:63], v[72:75], v[100:103], v[60:63]
    s_waitcnt vmcnt(11)
    ds_read_b64_tr_b16 v[64:65], v8 offset:6144
    ds_read_b64_tr_b16 v[66:67], v8 offset:7680
    ds_read_b64_tr_b16 v[68:69], v8 offset:6176
    ds_read_b64_tr_b16 v[70:71], v8 offset:7712
    ds_read_b64_tr_b16 v[72:73], v8 offset:6208
    ds_read_b64_tr_b16 v[74:75], v8 offset:7744
    s_waitcnt lgkmcnt(6)
    v_mfma_f32_16x16x32_bf16 v[16:19], v[76:79], v[104:107], v[16:19]
    v_mfma_f32_16x16x32_bf16 v[20:23], v[76:79], v[108:111], v[20:23]
    v_mfma_f32_16x16x32_bf16 v[24:27], v[76:79], v[112:115], v[24:27]
    v_mfma_f32_16x16x32_bf16 v[28:31], v[76:79], v[116:119], v[28:31]
    v_mfma_f32_16x16x32_bf16 v[32:35], v[80:83], v[104:107], v[32:35]
    v_mfma_f32_16x16x32_bf16 v[36:39], v[80:83], v[108:111], v[36:39]
    v_mfma_f32_16x16x32_bf16 v[40:43], v[80:83], v[112:115], v[40:43]
    v_mfma_f32_16x16x32_bf16 v[44:47], v[80:83], v[116:119], v[44:47]
    v_mfma_f32_16x16x32_bf16 v[48:51], v[84:87], v[104:107], v[48:51]
    v_mfma_f32_16x16x32_bf16 v[52:55], v[84:87], v[108:111], v[52:55]
    v_mfma_f32_16x16x32_bf16 v[56:59], v[84:87], v[112:115], v[56:59]
    v_mfma_f32_16x16x32_bf16 v[60:63], v[84:87], v[116:119], v[60:63]
    s_add_u32 m0, s62, 12288
    s_lshl_b32 s47, s63, 17
    s_add_u32 s47, s47, s46
    buffer_load_dwordx4 v248, s[48:51], s47 offen offset:0 lds
    buffer_load_dwordx4 v249, s[48:51], s47 offen offset:1024 lds
    buffer_load_dwordx4 v250, s[48:51], s47 offen offset:2048 lds
    buffer_load_dwordx4 v251, s[48:51], s47 offen offset:3072 lds
    s_add_u32 m0, s62, 16384
    s_add_u32 s63, s63, 1
    s_cmp_eq_u32 s63, 11
    s_cselect_b32 s63, 0, s63
    s_lshl_b32 s47, s63, 17
    s_add_u32 s47, s47, s46
    buffer_load_dwordx4 v248, s[48:51], s47 offen offset:0 lds
    buffer_load_dwordx4 v249, s[48:51], s47 offen offset:1024 lds
    buffer_load_dwordx4 v250, s[48:51], s47 offen offset:2048 lds
    buffer_load_dwordx4 v251, s[48:51], s47 offen offset:3072 lds
    s_waitcnt vmcnt(12)
    ds_read_b64_tr_b16 v[76:77], v8 offset:9216
    ds_read_b64_tr_b16 v[78:79], v8 offset:10752
    ds_read_b64_tr_b16 v[80:81], v8 offset:9248
    ds_read_b64_tr_b16 v[82:83], v8 offset:10784
    ds_read_b64_tr_b16 v[84:85], v8 offset:9280
    ds_read_b64_tr_b16 v[86:87], v8 offset:10816
    s_waitcnt lgkmcnt(6)
    v_mfma_f32_16x16x32_bf16 v[16:19], v[64:67], v[120:123], v[16:19]
    v_mfma_f32_16x16x32_bf16 v[20:23], v[64:67], v[124:127], v[20:23]
    v_mfma_f32_16x16x32_bf16 v[24:27], v[64:67], v[128:131], v[24:27]
    v_mfma_f32_16x16x32_bf16 v[28:31], v[64:67], v[132:135], v[28:31]
    v_mfma_f32_16x16x32_bf16 v[32:35], v[68:71], v[120:123], v[32:35]
    v_mfma_f32_16x16x32_bf16 v[36:39], v[68:71], v[124:127], v[36:39]
    v_mfma_f32_16x16x32_bf16 v[40:43], v[68:71], v[128:131], v[40:43]
    v_mfma_f32_16x16x32_bf16 v[44:47], v[68:71], v[132:135], v[44:47]
    v_mfma_f32_16x16x32_bf16 v[48:51], v[72:75], v[120:123], v[48:51]
    v_mfma_f32_16x16x32_bf16 v[52:55], v[72:75], v[124:127], v[52:55]
    v_mfma_f32_16x16x32_bf16 v[56:59], v[72:75], v[128:131], v[56:59]
    v_mfma_f32_16x16x32_bf16 v[60:63], v[72:75], v[132:135], v[60:63]
    s_waitcnt vmcnt(8)
    s_waitcnt lgkmcnt(0)
    v_mfma_f32_16x16x32_bf16 v[16:19], v[76:79], v[136:139], v[16:19]
    v_mfma_f32_16x16x32_bf16 v[20:23], v[76:79], v[140:143], v[20:23]
    v_mfma_f32_16x16x32_bf16 v[24:27], v[76:79], v[144:147], v[24:27]
    v_mfma_f32_16x16x32_bf16 v[28:31], v[76:79], v[148:151], v[28:31]
    v_mfma_f32_16x16x32_bf16 v[32:35], v[80:83], v[136:139], v[32:35]
    v_mfma_f32_16x16x32_bf16 v[36:39], v[80:83], v[140:143], v[36:39]
    v_mfma_f32_16x16x32_bf16 v[40:43], v[80:83], v[144:147], v[40:43]
    v_mfma_f32_16x16x32_bf16 v[44:47], v[80:83], v[148:151], v[44:47]
    v_mfma_f32_16x16x32_bf16 v[48:51], v[84:87], v[136:139], v[48:51]
    v_mfma_f32_16x16x32_bf16 v[52:55], v[84:87], v[140:143], v[52:55]
    v_mfma_f32_16x16x32_bf16 v[56:59], v[84:87], v[144:147], v[56:59]
    v_mfma_f32_16x16x32_bf16 v[60:63], v[84:87], v[148:151], v[60:63]
    v_lshlrev_b32 v4, 4, v1
    s_mul_i32 s22, s3, 20480
    v_add_u32 v5, s22, v4
    ds_write_b128 v5, v[16:19] offset:0
    ds_write_b128 v5, v[32:35] offset:1024
    ds_write_b128 v5, v[48:51] offset:2048
    ds_write_b128 v5, v[20:23] offset:3072
    ds_write_b128 v5, v[36:39] offset:4096
    ds_write_b128 v5, v[52:55] offset:5120
    ds_write_b128 v5, v[24:27] offset:6144
    ds_write_b128 v5, v[40:43] offset:7168
    ds_write_b128 v5, v[56:59] offset:8192
    ds_write_b128 v5, v[28:31] offset:9216
    ds_write_b128 v5, v[44:47] offset:10240
    ds_write_b128 v5, v[60:63] offset:11264
    s_mul_i32 s22, s3, 3072
    v_add_u32 v6, s22, v4
    s_lshl_b32 s22, s14, 2
    s_add_u32 s22, s22, s3
    s_mul_i32 s22, s22, 44032
    s_mul_i32 s23, s15, 3
    s_add_u32 s36, s23, 0
    s_lshr_b32 s37, s36, 1
    s_lshl_b32 s37, s37, 10
    s_add_u32 s38, s37, s22
    s_add_u32 s36, s23, 1
    s_lshr_b32 s37, s36, 1
    s_lshl_b32 s37, s37, 10
    s_add_u32 s39, s37, s22
    s_add_u32 s36, s23, 2
    s_lshr_b32 s37, s36, 1
    s_lshl_b32 s37, s37, 10
    s_add_u32 s40, s37, s22
    v_mov_b32 v76, 0xc0135761
    v_mov_b32 v77, 0xbdd2d3e8
    v_mov_b32 v78, 1.0
    v_lshlrev_b32 v64, 16, v10
    v_and_b32 v65, 0xffff0000, v10
    v_lshlrev_b32 v66, 16, v11
    v_and_b32 v67, 0xffff0000, v11
    v_lshlrev_b32 v68, 16, v12
    v_and_b32 v69, 0xffff0000, v12
    v_lshlrev_b32 v70, 16, v13
    v_and_b32 v71, 0xffff0000, v13
    v_lshlrev_b32 v72, 16, v14
    v_and_b32 v73, 0xffff0000, v14
    v_lshlrev_b32 v74, 16, v15
    v_and_b32 v75, 0xffff0000, v15
    s_waitcnt lgkmcnt(0)
    s_barrier
    s_waitcnt vmcnt(0)
    ds_read_b64_tr_b16 v[152:153], v252 offset:12288
    ds_read_b64_tr_b16 v[154:155], v252 offset:13312
    ds_read_b64_tr_b16 v[156:157], v253 offset:12288
    ds_read_b64_tr_b16 v[158:159], v253 offset:13312
    ds_read_b64_tr_b16 v[160:161], v254 offset:12288
    ds_read_b64_tr_b16 v[162:163], v254 offset:13312
    ds_read_b64_tr_b16 v[164:165], v255 offset:12288
    ds_read_b64_tr_b16 v[166:167], v255 offset:13312
    ds_read_b64_tr_b16 v[168:169], v252 offset:16384
    ds_read_b64_tr_b16 v[170:171], v252 offset:17408
    ds_read_b64_tr_b16 v[172:173], v253 offset:16384
    ds_read_b64_tr_b16 v[174:175], v253 offset:17408
    ds_read_b64_tr_b16 v[176:177], v254 offset:16384
    ds_read_b64_tr_b16 v[178:179], v254 offset:17408
    ds_read_b64_tr_b16 v[180:181], v255 offset:16384
    ds_read_b64_tr_b16 v[182:183], v255 offset:17408
    ds_read_b128 v[88:91], v6 offset:0
    ds_read_b128 v[92:95], v6 offset:20480
    ds_read_b128 v[96:99], v6 offset:40960
    ds_read_b128 v[100:103], v6 offset:61440
    ds_read_b128 v[104:107], v6 offset:1024
    ds_read_b128 v[108:111], v6 offset:21504
    ds_read_b128 v[112:115], v6 offset:41984
    ds_read_b128 v[116:119], v6 offset:62464
    ds_read_b128 v[120:123], v6 offset:2048
    ds_read_b128 v[124:127], v6 offset:22528
    ds_read_b128 v[128:131], v6 offset:43008
    ds_read_b128 v[132:135], v6 offset:63488
    s_waitcnt lgkmcnt(8)
    s_add_u32 m0, s62, 12288
    s_add_u32 s63, s63, 1
    s_cmp_eq_u32 s63, 11
    s_cselect_b32 s63, 0, s63
    s_lshl_b32 s47, s63, 17
    s_add_u32 s47, s47, s46
    buffer_load_dwordx4 v248, s[48:51], s47 offen offset:0 lds
    buffer_load_dwordx4 v249, s[48:51], s47 offen offset:1024 lds
    buffer_load_dwordx4 v250, s[48:51], s47 offen offset:2048 lds
    buffer_load_dwordx4 v251, s[48:51], s47 offen offset:3072 lds
    s_add_u32 m0, s62, 16384
    s_add_u32 s63, s63, 1
    s_cmp_eq_u32 s63, 11
    s_cselect_b32 s63, 0, s63
    s_lshl_b32 s47, s63, 17
    s_add_u32 s47, s47, s46
    buffer_load_dwordx4 v248, s[48:51], s47 offen offset:0 lds
    buffer_load_dwordx4 v249, s[48:51], s47 offen offset:1024 lds
    buffer_load_dwordx4 v250, s[48:51], s47 offen offset:2048 lds
    buffer_load_dwordx4 v251, s[48:51], s47 offen offset:3072 lds
    v_pk_add_f32 v[88:89], v[88:89], v[92:93]
    v_pk_add_f32 v[96:97], v[96:97], v[100:101]
    v_pk_add_f32 v[90:91], v[90:91], v[94:95]
    v_pk_add_f32 v[98:99], v[98:99], v[102:103]
    v_pk_add_f32 v[88:89], v[88:89], v[96:97]
    v_pk_add_f32 v[90:91], v[90:91], v[98:99]
    v_cvt_pk_bf16_f32 v40, v88, v89
    v_cvt_pk_bf16_f32 v41, v90, v91
    v_lshlrev_b32 v88, 16, v40
    v_and_b32 v89, 0xffff0000, v40
    v_lshlrev_b32 v90, 16, v41
    v_and_b32 v91, 0xffff0000, v41
    v_pk_add_f32 v[88:89], v[88:89], v[64:65]
    v_pk_add_f32 v[90:91], v[90:91], v[66:67]
    v_cvt_pk_bf16_f32 v40, v88, v89
    v_cvt_pk_bf16_f32 v41, v90, v91
    v_lshlrev_b32 v88, 16, v40
    v_and_b32 v89, 0xffff0000, v40
    v_lshlrev_b32 v90, 16, v41
    v_and_b32 v91, 0xffff0000, v41
    v_pk_mul_f32 v[44:45], v[88:89], v[88:89]
    v_pk_mul_f32 v[46:47], v[90:91], v[90:91]
    v_pk_fma_f32 v[44:45], v[44:45], v[76:77], v[76:77] op_sel:[0,1,0] op_sel_hi:[1,1,0]
    v_pk_fma_f32 v[46:47], v[46:47], v[76:77], v[76:77] op_sel:[0,1,0] op_sel_hi:[1,1,0]
    v_pk_mul_f32 v[44:45], v[44:45], v[88:89]
    v_pk_mul_f32 v[46:47], v[46:47], v[90:91]
    v_exp_f32 v44, v44
    v_exp_f32 v45, v45
    v_exp_f32 v46, v46
    v_exp_f32 v47, v47
    v_pk_add_f32 v[44:45], v[44:45], v[78:79] op_sel_hi:[1,0]
    v_pk_add_f32 v[46:47], v[46:47], v[78:79] op_sel_hi:[1,0]
    v_rcp_f32 v44, v44
    v_rcp_f32 v45, v45
    v_rcp_f32 v46, v46
    v_rcp_f32 v47, v47
    v_pk_mul_f32 v[88:89], v[88:89], v[44:45]
    v_pk_mul_f32 v[90:91], v[90:91], v[46:47]
    v_cvt_pk_bf16_f32 v48, v88, v89
    v_cvt_pk_bf16_f32 v49, v90, v91
    s_mov_b32 s36, 0
    s_mov_b32 s37, -1
    s_bitcmp0_b32 s15, 0
    s_cbranch_scc1 K4_S0
    v_mov_b32 v58, v48
    v_mov_b32 v59, v49
    v_mov_b32 v56, v48
    v_mov_b32 v57, v49
    s_nop 1
    v_permlane32_swap_b32 v56, v58
    v_permlane32_swap_b32 v57, v59
    s_mov_b64 exec, s[36:37]
    buffer_store_dwordx4 v[56:59], v4, s[32:35], s38 offen sc0 sc1
    s_mov_b64 exec, -1
K4_S0:
    s_waitcnt lgkmcnt(4)
    v_pk_add_f32 v[104:105], v[104:105], v[108:109]
    v_pk_add_f32 v[112:113], v[112:113], v[116:117]
    v_pk_add_f32 v[106:107], v[106:107], v[110:111]
    v_pk_add_f32 v[114:115], v[114:115], v[118:119]
    v_pk_add_f32 v[104:105], v[104:105], v[112:113]
    v_pk_add_f32 v[106:107], v[106:107], v[114:115]
    v_cvt_pk_bf16_f32 v40, v104, v105
    v_cvt_pk_bf16_f32 v41, v106, v107
    v_lshlrev_b32 v104, 16, v40
    v_and_b32 v105, 0xffff0000, v40
    v_lshlrev_b32 v106, 16, v41
    v_and_b32 v107, 0xffff0000, v41
    v_pk_add_f32 v[104:105], v[104:105], v[68:69]
    v_pk_add_f32 v[106:107], v[106:107], v[70:71]
    v_cvt_pk_bf16_f32 v40, v104, v105
    v_cvt_pk_bf16_f32 v41, v106, v107
    v_lshlrev_b32 v104, 16, v40
    v_and_b32 v105, 0xffff0000, v40
    v_lshlrev_b32 v106, 16, v41
    v_and_b32 v107, 0xffff0000, v41
    v_pk_mul_f32 v[44:45], v[104:105], v[104:105]
    v_pk_mul_f32 v[46:47], v[106:107], v[106:107]
    v_pk_fma_f32 v[44:45], v[44:45], v[76:77], v[76:77] op_sel:[0,1,0] op_sel_hi:[1,1,0]
    v_pk_fma_f32 v[46:47], v[46:47], v[76:77], v[76:77] op_sel:[0,1,0] op_sel_hi:[1,1,0]
    v_pk_mul_f32 v[44:45], v[44:45], v[104:105]
    v_pk_mul_f32 v[46:47], v[46:47], v[106:107]
    v_exp_f32 v44, v44
    v_exp_f32 v45, v45
    v_exp_f32 v46, v46
    v_exp_f32 v47, v47
    v_pk_add_f32 v[44:45], v[44:45], v[78:79] op_sel_hi:[1,0]
    v_pk_add_f32 v[46:47], v[46:47], v[78:79] op_sel_hi:[1,0]
    v_rcp_f32 v44, v44
    v_rcp_f32 v45, v45
    v_rcp_f32 v46, v46
    v_rcp_f32 v47, v47
    v_pk_mul_f32 v[104:105], v[104:105], v[44:45]
    v_pk_mul_f32 v[106:107], v[106:107], v[46:47]
    v_cvt_pk_bf16_f32 v50, v104, v105
    v_cvt_pk_bf16_f32 v51, v106, v107
    s_bitcmp1_b32 s15, 0
    s_cbranch_scc1 K4_S1
    s_nop 1
    v_permlane32_swap_b32 v48, v50
    v_permlane32_swap_b32 v49, v51
    buffer_store_dwordx4 v[48:51], v4, s[32:35], s38 offen sc0 sc1
K4_S1:
    s_waitcnt lgkmcnt(0)
    v_pk_add_f32 v[120:121], v[120:121], v[124:125]
    v_pk_add_f32 v[128:129], v[128:129], v[132:133]
    v_pk_add_f32 v[122:123], v[122:123], v[126:127]
    v_pk_add_f32 v[130:131], v[130:131], v[134:135]
    v_pk_add_f32 v[120:121], v[120:121], v[128:129]
    v_pk_add_f32 v[122:123], v[122:123], v[130:131]
    v_cvt_pk_bf16_f32 v40, v120, v121
    v_cvt_pk_bf16_f32 v41, v122, v123
    v_lshlrev_b32 v120, 16, v40
    v_and_b32 v121, 0xffff0000, v40
    v_lshlrev_b32 v122, 16, v41
    v_and_b32 v123, 0xffff0000, v41
    v_pk_add_f32 v[120:121], v[120:121], v[72:73]
    v_pk_add_f32 v[122:123], v[122:123], v[74:75]
    v_cvt_pk_bf16_f32 v40, v120, v121
    v_cvt_pk_bf16_f32 v41, v122, v123
    v_lshlrev_b32 v120, 16, v40
    v_and_b32 v121, 0xffff0000, v40
    v_lshlrev_b32 v122, 16, v41
    v_and_b32 v123, 0xffff0000, v41
    v_pk_mul_f32 v[44:45], v[120:121], v[120:121]
    v_pk_mul_f32 v[46:47], v[122:123], v[122:123]
    v_pk_fma_f32 v[44:45], v[44:45], v[76:77], v[76:77] op_sel:[0,1,0] op_sel_hi:[1,1,0]
    v_pk_fma_f32 v[46:47], v[46:47], v[76:77], v[76:77] op_sel:[0,1,0] op_sel_hi:[1,1,0]
    v_pk_mul_f32 v[44:45], v[44:45], v[120:121]
    v_pk_mul_f32 v[46:47], v[46:47], v[122:123]
    v_exp_f32 v44, v44
    v_exp_f32 v45, v45
    v_exp_f32 v46, v46
    v_exp_f32 v47, v47
    v_pk_add_f32 v[44:45], v[44:45], v[78:79] op_sel_hi:[1,0]
    v_pk_add_f32 v[46:47], v[46:47], v[78:79] op_sel_hi:[1,0]
    v_rcp_f32 v44, v44
    v_rcp_f32 v45, v45
    v_rcp_f32 v46, v46
    v_rcp_f32 v47, v47
    v_pk_mul_f32 v[120:121], v[120:121], v[44:45]
    v_pk_mul_f32 v[122:123], v[122:123], v[46:47]
    v_cvt_pk_bf16_f32 v52, v120, v121
    v_cvt_pk_bf16_f32 v53, v122, v123
    s_mov_b32 s36, -1
    s_mov_b32 s37, 0
    s_bitcmp1_b32 s15, 0
    s_cbranch_scc1 K4_S2
    s_cmp_eq_u32 s15, 28
    s_cbranch_scc1 K4_FL28
    v_mov_b32 v54, v52
    v_mov_b32 v55, v53
    s_nop 1
    v_permlane32_swap_b32 v52, v54
    v_permlane32_swap_b32 v53, v55
    s_mov_b64 exec, s[36:37]
    buffer_store_dwordx4 v[52:55], v4, s[32:35], s40 offen sc0 sc1
    s_mov_b64 exec, -1
    s_branch K4_FL
K4_FL28:
    s_waitcnt vmcnt(0)
    s_branch K4_FL
K4_S2:
    s_nop 1
    v_permlane32_swap_b32 v50, v52
    v_permlane32_swap_b32 v51, v53
    buffer_store_dwordx4 v[50:53], v4, s[32:35], s39 offen sc0 sc1
K4_FL:
    s_add_u32 s4, s12, 0x1f00000
    s_addc_u32 s5, s13, 0
    s_and_b32 s5, s5, 0xffff
    s_mov_b32 s6, 0x8000
    s_mov_b32 s7, 0x20000
    s_lshl_b32 s54, s14, 12
    s_lshl_b32 s55, s15, 7
    s_add_u32 s54, s54, s55
    v_mov_b32 v6, 0
    v_mov_b32 v7, 1
    s_waitcnt vmcnt(2)
    ds_read_b64_tr_b16 v[184:185], v252 offset:12288
    ds_read_b64_tr_b16 v[186:187], v252 offset:13312
    ds_read_b64_tr_b16 v[188:189], v253 offset:12288
    ds_read_b64_tr_b16 v[190:191], v253 offset:13312
    ds_read_b64_tr_b16 v[192:193], v254 offset:12288
    ds_read_b64_tr_b16 v[194:195], v254 offset:13312
    ds_read_b64_tr_b16 v[196:197], v255 offset:12288
    ds_read_b64_tr_b16 v[198:199], v255 offset:13312
    ds_read_b64_tr_b16 v[200:201], v252 offset:16384
    ds_read_b64_tr_b16 v[202:203], v252 offset:17408
    ds_read_b64_tr_b16 v[204:205], v253 offset:16384
    ds_read_b64_tr_b16 v[206:207], v253 offset:17408
    ds_read_b64_tr_b16 v[208:209], v254 offset:16384
    ds_read_b64_tr_b16 v[210:211], v254 offset:17408
    ds_read_b64_tr_b16 v[212:213], v255 offset:16384
    ds_read_b64_tr_b16 v[214:215], v255 offset:17408
    s_waitcnt vmcnt(0) lgkmcnt(0)
    s_barrier
    s_cmp_lg_u32 s3, 0
    s_cbranch_scc1 P2
    s_mov_b64 exec, 1
    buffer_store_dword v7, v6, s[4:7], s54 offen sc0 sc1
    s_mov_b64 exec, -1
    s_branch P2
P2_IDLE:
    s_waitcnt lgkmcnt(0)
    s_add_u32 s4, s12, 0x1f00000
    s_addc_u32 s5, s13, 0
    s_and_b32 s5, s5, 0xffff
    s_mov_b32 s6, 0x8000
    s_mov_b32 s7, 0x20000
    s_mov_b32 s48, s56
    s_and_b32 s49, s57, 0xffff
    s_mov_b32 s50, 0x560000
    s_mov_b32 s51, 0x20000
    s_lshr_b32 s47, s2, 3
    s_and_b32 s63, s47, 3
    s_mul_i32 s63, s63, 3
    s_lshr_b32 s47, s47, 2
    s_and_b32 s46, s47, 7
    s_mul_i32 s46, s46, 1
    s_add_u32 s63, s63, s46
    s_bfe_u32 s46, s2, 0x20001
    s_lshl_b32 s46, s46, 3
    s_add_u32 s46, s46, s47
    s_lshl_b32 s46, s46, 7
    s_mul_i32 s47, s3, 1441792
    s_add_u32 s46, s46, s47
    s_sub_u32 s47, s63, 11
    s_cmp_ge_u32 s63, 11
    s_cselect_b32 s63, s47, s63
    s_mul_i32 s62, s3, 20480
    v_lshrrev_b32 v249, 3, v1
    v_bfe_u32 v250, v249, 1, 2
    v_lshlrev_b32 v250, 1, v250
    v_and_b32 v251, 7, v1
    v_xor_b32 v250, v250, v251
    v_lshlrev_b32 v250, 4, v250
    v_lshl_add_u32 v248, v249, 12, v250
    v_add_u32 v249, 31744, v248
    v_add_u32 v250, 63488, v248
    v_add_u32 v251, 95232, v248
    v_bfe_u32 v253, v1, 2, 2
    v_bfe_u32 v254, v1, 4, 1
    v_lshl_add_u32 v253, v254, 2, v253
    v_lshrrev_b32 v254, 5, v1
    v_lshl_add_u32 v253, v254, 4, v253
    v_bfe_u32 v254, v253, 1, 2
    v_lshlrev_b32 v253, 7, v253
    v_lshl_add_u32 v253, v254, 5, v253
    v_and_b32 v254, 3, v1
    v_lshl_add_u32 v253, v254, 3, v253
    v_add_u32 v252, s62, v253
    v_xor_b32 v253, 32, v252
    v_xor_b32 v254, 64, v252
    v_xor_b32 v255, 96, v252
    s_add_u32 m0, s62, 0
    s_lshl_b32 s47, s63, 17
    s_add_u32 s47, s47, s46
    buffer_load_dwordx4 v248, s[48:51], s47 offen offset:0 lds
    buffer_load_dwordx4 v249, s[48:51], s47 offen offset:1024 lds
    buffer_load_dwordx4 v250, s[48:51], s47 offen offset:2048 lds
    buffer_load_dwordx4 v251, s[48:51], s47 offen offset:3072 lds
    s_add_u32 m0, s62, 4096
    s_add_u32 s63, s63, 1
    s_cmp_eq_u32 s63, 11
    s_cselect_b32 s63, 0, s63
    s_lshl_b32 s47, s63, 17
    s_add_u32 s47, s47, s46
    buffer_load_dwordx4 v248, s[48:51], s47 offen offset:0 lds
    buffer_load_dwordx4 v249, s[48:51], s47 offen offset:1024 lds
    buffer_load_dwordx4 v250, s[48:51], s47 offen offset:2048 lds
    buffer_load_dwordx4 v251, s[48:51], s47 offen offset:3072 lds
    s_add_u32 m0, s62, 8192
    s_add_u32 s63, s63, 1
    s_cmp_eq_u32 s63, 11
    s_cselect_b32 s63, 0, s63
    s_lshl_b32 s47, s63, 17
    s_add_u32 s47, s47, s46
    buffer_load_dwordx4 v248, s[48:51], s47 offen offset:0 lds
    buffer_load_dwordx4 v249, s[48:51], s47 offen offset:1024 lds
    buffer_load_dwordx4 v250, s[48:51], s47 offen offset:2048 lds
    buffer_load_dwordx4 v251, s[48:51], s47 offen offset:3072 lds
    s_add_u32 m0, s62, 12288
    s_add_u32 s63, s63, 1
    s_cmp_eq_u32 s63, 11
    s_cselect_b32 s63, 0, s63
    s_lshl_b32 s47, s63, 17
    s_add_u32 s47, s47, s46
    buffer_load_dwordx4 v248, s[48:51], s47 offen offset:0 lds
    buffer_load_dwordx4 v249, s[48:51], s47 offen offset:1024 lds
    buffer_load_dwordx4 v250, s[48:51], s47 offen offset:2048 lds
    buffer_load_dwordx4 v251, s[48:51], s47 offen offset:3072 lds
    v_lshrrev_b32 v12, 3, v1
    v_lshlrev_b32 v12, 12, v12
    v_and_b32 v13, 7, v1
    v_lshl_add_u32 v12, v13, 7, v12
    s_lshr_b32 s52, s2, 3
    s_sub_u32 s52, s52, 29
    s_lshl_b32 s52, s52, 2
    s_add_u32 s52, s52, s3
    s_lshl_b32 s52, s52, 1
    s_and_b32 s53, s2, 1
    s_add_u32 s52, s52, s53
    s_lshl_b32 s52, s52, 15
    s_bfe_u32 s53, s2, 0x20001
    s_lshl_b32 s53, s53, 10
    s_add_u32 s52, s52, s53
    buffer_load_dword v13, v12, s[48:51], s52 offen
    s_add_u32 s52, s52, 786432
    buffer_load_dword v13, v12, s[48:51], s52 offen
    s_add_u32 s52, s52, 786432
    buffer_load_dword v13, v12, s[48:51], s52 offen
    s_add_u32 s52, s52, 786432
    buffer_load_dword v13, v12, s[48:51], s52 offen
    s_add_u32 s52, s52, 786432
    buffer_load_dword v13, v12, s[48:51], s52 offen
    s_add_u32 s52, s52, 786432
    buffer_load_dword v13, v12, s[48:51], s52 offen
    s_add_u32 s52, s52, 786432
    buffer_load_dword v13, v12, s[48:51], s52 offen
    s_add_u32 s52, s52, 786432
    buffer_load_dword v13, v12, s[48:51], s52 offen
    s_waitcnt vmcnt(8)
    ds_read_b64_tr_b16 v[152:153], v252 offset:0
    ds_read_b64_tr_b16 v[154:155], v252 offset:1024
    ds_read_b64_tr_b16 v[156:157], v253 offset:0
    ds_read_b64_tr_b16 v[158:159], v253 offset:1024
    ds_read_b64_tr_b16 v[160:161], v254 offset:0
    ds_read_b64_tr_b16 v[162:163], v254 offset:1024
    ds_read_b64_tr_b16 v[164:165], v255 offset:0
    ds_read_b64_tr_b16 v[166:167], v255 offset:1024
    ds_read_b64_tr_b16 v[168:169], v252 offset:4096
    ds_read_b64_tr_b16 v[170:171], v252 offset:5120
    ds_read_b64_tr_b16 v[172:173], v253 offset:4096
    ds_read_b64_tr_b16 v[174:175], v253 offset:5120
    ds_read_b64_tr_b16 v[176:177], v254 offset:4096
    ds_read_b64_tr_b16 v[178:179], v254 offset:5120
    ds_read_b64_tr_b16 v[180:181], v255 offset:4096
    ds_read_b64_tr_b16 v[182:183], v255 offset:5120
    s_waitcnt lgkmcnt(0)
    ds_read_b64_tr_b16 v[184:185], v252 offset:8192
    ds_read_b64_tr_b16 v[186:187], v252 offset:9216
    ds_read_b64_tr_b16 v[188:189], v253 offset:8192
    ds_read_b64_tr_b16 v[190:191], v253 offset:9216
    ds_read_b64_tr_b16 v[192:193], v254 offset:8192
    ds_read_b64_tr_b16 v[194:195], v254 offset:9216
    ds_read_b64_tr_b16 v[196:197], v255 offset:8192
    ds_read_b64_tr_b16 v[198:199], v255 offset:9216
    ds_read_b64_tr_b16 v[200:201], v252 offset:12288
    ds_read_b64_tr_b16 v[202:203], v252 offset:13312
    ds_read_b64_tr_b16 v[204:205], v253 offset:12288
    ds_read_b64_tr_b16 v[206:207], v253 offset:13312
    ds_read_b64_tr_b16 v[208:209], v254 offset:12288
    ds_read_b64_tr_b16 v[210:211], v254 offset:13312
    ds_read_b64_tr_b16 v[212:213], v255 offset:12288
    ds_read_b64_tr_b16 v[214:215], v255 offset:13312
    s_waitcnt lgkmcnt(0)
P2:
    s_and_b32 s14, s2, 7
    s_lshr_b32 s15, s2, 3
    s_and_b32 s16, s14, 1
    s_lshl_b32 s16, s16, 2
    s_and_b32 s17, s15, 3
    s_add_u32 s16, s16, s17
    s_lshr_b32 s14, s14, 1
    s_lshl_b32 s14, s14, 3
    s_lshr_b32 s15, s15, 2
    s_add_u32 s15, s15, s14
    v_lshrrev_b32 v2, 4, v1
    v_and_b32 v3, 15, v1
    v_lshlrev_b32 v8, 4, v1
    s_mul_i32 s20, s16, 176128
    s_mul_i32 s21, s3, 11264
    s_add_u32 s20, s20, s21
    v_lshlrev_b32 v9, 10, v3
    v_lshl_add_u32 v9, v2, 5, v9
    s_lshl_b32 s21, s15, 6
    s_lshl_b32 s22, s3, 4
    s_add_u32 s21, s21, s22
    s_lshl_b32 s22, s21, 10
    s_lshl_b32 s23, s16, 7
    s_add_u32 s22, s22, s23
    s_lshl_b32 s21, s21, 1
    v_lshlrev_b32 v10, 1, v3
    s_add_u32 m0, s62, 0
    s_add_u32 s63, s63, 1
    s_cmp_eq_u32 s63, 11
    s_cselect_b32 s63, 0, s63
    s_lshl_b32 s47, s63, 17
    s_add_u32 s47, s47, s46
    buffer_load_dwordx4 v248, s[48:51], s47 offen offset:0 lds
    buffer_load_dwordx4 v249, s[48:51], s47 offen offset:1024 lds
    buffer_load_dwordx4 v250, s[48:51], s47 offen offset:2048 lds
    buffer_load_dwordx4 v251, s[48:51], s47 offen offset:3072 lds
    s_add_u32 m0, s62, 4096
    s_add_u32 s63, s63, 1
    s_cmp_eq_u32 s63, 11
    s_cselect_b32 s63, 0, s63
    s_lshl_b32 s47, s63, 17
    s_add_u32 s47, s47, s46
    buffer_load_dwordx4 v248, s[48:51], s47 offen offset:0 lds
    buffer_load_dwordx4 v249, s[48:51], s47 offen offset:1024 lds
    buffer_load_dwordx4 v250, s[48:51], s47 offen offset:2048 lds
    buffer_load_dwordx4 v251, s[48:51], s47 offen offset:3072 lds
    s_add_u32 m0, s62, 8192
    s_add_u32 s63, s63, 1
    s_cmp_eq_u32 s63, 11
    s_cselect_b32 s63, 0, s63
    s_lshl_b32 s47, s63, 17
    s_add_u32 s47, s47, s46
    buffer_load_dwordx4 v248, s[48:51], s47 offen offset:0 lds
    buffer_load_dwordx4 v249, s[48:51], s47 offen offset:1024 lds
    buffer_load_dwordx4 v250, s[48:51], s47 offen offset:2048 lds
    buffer_load_dwordx4 v251, s[48:51], s47 offen offset:3072 lds
    s_add_u32 m0, s62, 12288
    s_add_u32 s63, s63, 1
    s_cmp_eq_u32 s63, 11
    s_cselect_b32 s63, 0, s63
    s_lshl_b32 s47, s63, 17
    s_add_u32 s47, s47, s46
    buffer_load_dwordx4 v248, s[48:51], s47 offen offset:0 lds
    buffer_load_dwordx4 v249, s[48:51], s47 offen offset:1024 lds
    buffer_load_dwordx4 v250, s[48:51], s47 offen offset:2048 lds
    buffer_load_dwordx4 v251, s[48:51], s47 offen offset:3072 lds
    s_add_u32 m0, s62, 16384
    s_add_u32 s63, s63, 1
    s_cmp_eq_u32 s63, 11
    s_cselect_b32 s63, 0, s63
    s_lshl_b32 s47, s63, 17
    s_add_u32 s47, s47, s46
    buffer_load_dwordx4 v248, s[48:51], s47 offen offset:0 lds
    buffer_load_dwordx4 v249, s[48:51], s47 offen offset:1024 lds
    buffer_load_dwordx4 v250, s[48:51], s47 offen offset:2048 lds
    buffer_load_dwordx4 v251, s[48:51], s47 offen offset:3072 lds
    s_add_u32 s24, s12, 0xf00000
    s_addc_u32 s25, s13, 0
    s_and_b32 s25, s25, 0xffff
    s_mov_b32 s26, 0x158000
    s_mov_b32 s27, 0x20000
    s_mov_b32 s28, s58
    s_and_b32 s29, s59, 0xffff
    s_mov_b32 s30, 0x1000
    s_mov_b32 s31, 0x20000
    s_add_u32 s32, s12, 0x900000
    s_addc_u32 s33, s13, 0
    s_and_b32 s33, s33, 0xffff
    s_mov_b32 s34, 0x200000
    s_mov_b32 s35, 0x20000
    s_mov_b32 s36, s60
    s_and_b32 s37, s61, 0xffff
    s_mov_b32 s38, 0x200000
    s_mov_b32 s39, 0x20000
    s_and_b32 s43, s16, 3
    s_mul_i32 s43, s43, 3
    s_and_b32 s45, s15, 7
    s_mul_i32 s45, s45, 1
    s_add_u32 s43, s43, s45
    s_sub_u32 s45, s43, 11
    s_cmp_ge_u32 s43, 11
    s_cselect_b32 s43, s45, s43
    s_cmp_eq_u32 s3, 3
    s_cselect_b32 s44, 10, 99
    buffer_load_dwordx4 v[16:19], v9, s[32:35], s22 offen
    buffer_load_dwordx4 v[20:23], v9, s[32:35], s22 offen offset:16
    buffer_load_ushort v11, v10, s[28:31], s21 offen
    s_waitcnt vmcnt(19)
    ds_read_b64_tr_b16 v[216:217], v252 offset:0
    ds_read_b64_tr_b16 v[218:219], v252 offset:1024
    ds_read_b64_tr_b16 v[220:221], v253 offset:0
    ds_read_b64_tr_b16 v[222:223], v253 offset:1024
    ds_read_b64_tr_b16 v[224:225], v254 offset:0
    ds_read_b64_tr_b16 v[226:227], v254 offset:1024
    ds_read_b64_tr_b16 v[228:229], v255 offset:0
    ds_read_b64_tr_b16 v[230:231], v255 offset:1024
    s_waitcnt vmcnt(15)
    ds_read_b64_tr_b16 v[232:233], v252 offset:4096
    ds_read_b64_tr_b16 v[234:235], v252 offset:5120
    ds_read_b64_tr_b16 v[236:237], v253 offset:4096
    ds_read_b64_tr_b16 v[238:239], v253 offset:5120
    ds_read_b64_tr_b16 v[240:241], v254 offset:4096
    ds_read_b64_tr_b16 v[242:243], v254 offset:5120
    ds_read_b64_tr_b16 v[244:245], v255 offset:4096
    ds_read_b64_tr_b16 v[246:247], v255 offset:5120
    s_waitcnt lgkmcnt(0)
    s_add_u32 m0, s62, 0
    s_add_u32 s63, s63, 1
    s_cmp_eq_u32 s63, 11
    s_cselect_b32 s63, 0, s63
    s_lshl_b32 s47, s63, 17
    s_add_u32 s47, s47, s46
    buffer_load_dwordx4 v248, s[48:51], s47 offen offset:0 lds
    buffer_load_dwordx4 v249, s[48:51], s47 offen offset:1024 lds
    buffer_load_dwordx4 v250, s[48:51], s47 offen offset:2048 lds
    buffer_load_dwordx4 v251, s[48:51], s47 offen offset:3072 lds
    s_add_u32 m0, s62, 4096
    s_add_u32 s63, s63, 1
    s_cmp_eq_u32 s63, 11
    s_cselect_b32 s63, 0, s63
    s_lshl_b32 s47, s63, 17
    s_add_u32 s47, s47, s46
    buffer_load_dwordx4 v248, s[48:51], s47 offen offset:0 lds
    buffer_load_dwordx4 v249, s[48:51], s47 offen offset:1024 lds
    buffer_load_dwordx4 v250, s[48:51], s47 offen offset:2048 lds
    buffer_load_dwordx4 v251, s[48:51], s47 offen offset:3072 lds
    s_cmp_lg_u32 s3, 0
    s_cbranch_scc1 P2_GO
    s_lshl_b32 s55, s16, 12
    v_min_u32 v88, 28, v1
    v_lshlrev_b32 v88, 7, v88
    s_mov_b32 s52, 200000
P2_POLL:
    buffer_load_dword v89, v88, s[4:7], s55 offen sc1
    s_sub_u32 s52, s52, 1
    s_waitcnt vmcnt(0)
    v_cmp_ne_u32 vcc, 0, v89
    s_cmp_eq_u32 s52, 0
    s_cbranch_scc1 P2_GO
    s_cmp_eq_u64 vcc, -1
    s_cbranch_scc0 P2_POLL
P2_GO:
    s_barrier
    s_lshl_b32 s42, s43, 10
    s_add_u32 s42, s42, s20
    s_cmp_eq_u32 s43, s44
    s_cselect_b32 s42, 0x7000000, s42
    buffer_load_dwordx4 v[88:91], v8, s[24:27], s42 offen sc1
    s_add_u32 s42, s42, 44032
    buffer_load_dwordx4 v[92:95], v8, s[24:27], s42 offen sc1
    s_add_u32 s42, s42, 44032
    buffer_load_dwordx4 v[96:99], v8, s[24:27], s42 offen sc1
    s_add_u32 s42, s42, 44032
    buffer_load_dwordx4 v[100:103], v8, s[24:27], s42 offen sc1
    s_add_u32 s43, s43, 1
    s_cmp_eq_u32 s43, 11
    s_cselect_b32 s43, 0, s43
    s_lshl_b32 s42, s43, 10
    s_add_u32 s42, s42, s20
    s_cmp_eq_u32 s43, s44
    s_cselect_b32 s42, 0x7000000, s42
    buffer_load_dwordx4 v[104:107], v8, s[24:27], s42 offen sc1
    s_add_u32 s42, s42, 44032
    buffer_load_dwordx4 v[108:111], v8, s[24:27], s42 offen sc1
    s_add_u32 s42, s42, 44032
    buffer_load_dwordx4 v[112:115], v8, s[24:27], s42 offen sc1
    s_add_u32 s42, s42, 44032
    buffer_load_dwordx4 v[116:119], v8, s[24:27], s42 offen sc1
    s_add_u32 s43, s43, 1
    s_cmp_eq_u32 s43, 11
    s_cselect_b32 s43, 0, s43
    s_lshl_b32 s42, s43, 10
    s_add_u32 s42, s42, s20
    s_cmp_eq_u32 s43, s44
    s_cselect_b32 s42, 0x7000000, s42
    buffer_load_dwordx4 v[120:123], v8, s[24:27], s42 offen sc1
    s_add_u32 s42, s42, 44032
    buffer_load_dwordx4 v[124:127], v8, s[24:27], s42 offen sc1
    s_add_u32 s42, s42, 44032
    buffer_load_dwordx4 v[128:131], v8, s[24:27], s42 offen sc1
    s_add_u32 s42, s42, 44032
    buffer_load_dwordx4 v[132:135], v8, s[24:27], s42 offen sc1
    s_add_u32 s43, s43, 1
    s_cmp_eq_u32 s43, 11
    s_cselect_b32 s43, 0, s43
    s_lshl_b32 s42, s43, 10
    s_add_u32 s42, s42, s20
    s_cmp_eq_u32 s43, s44
    s_cselect_b32 s42, 0x7000000, s42
    buffer_load_dwordx4 v[136:139], v8, s[24:27], s42 offen sc1
    s_add_u32 s42, s42, 44032
    buffer_load_dwordx4 v[140:143], v8, s[24:27], s42 offen sc1
    s_add_u32 s42, s42, 44032
    buffer_load_dwordx4 v[144:147], v8, s[24:27], s42 offen sc1
    s_add_u32 s42, s42, 44032
    buffer_load_dwordx4 v[148:151], v8, s[24:27], s42 offen sc1
    s_waitcnt vmcnt(12)
    v_mfma_f32_16x16x32_bf16 v[24:27], v[88:91], v[152:155], 0
    v_mfma_f32_16x16x32_bf16 v[28:31], v[88:91], v[156:159], 0
    v_mfma_f32_16x16x32_bf16 v[32:35], v[88:91], v[160:163], 0
    v_mfma_f32_16x16x32_bf16 v[36:39], v[88:91], v[164:167], 0
    v_mfma_f32_16x16x32_bf16 v[40:43], v[92:95], v[152:155], 0
    v_mfma_f32_16x16x32_bf16 v[44:47], v[92:95], v[156:159], 0
    v_mfma_f32_16x16x32_bf16 v[48:51], v[92:95], v[160:163], 0
    v_mfma_f32_16x16x32_bf16 v[52:55], v[92:95], v[164:167], 0
    v_mfma_f32_16x16x32_bf16 v[56:59], v[96:99], v[152:155], 0
    v_mfma_f32_16x16x32_bf16 v[60:63], v[96:99], v[156:159], 0
    v_mfma_f32_16x16x32_bf16 v[64:67], v[96:99], v[160:163], 0
    v_mfma_f32_16x16x32_bf16 v[68:71], v[96:99], v[164:167], 0
    v_mfma_f32_16x16x32_bf16 v[72:75], v[100:103], v[152:155], 0
    v_mfma_f32_16x16x32_bf16 v[76:79], v[100:103], v[156:159], 0
    v_mfma_f32_16x16x32_bf16 v[80:83], v[100:103], v[160:163], 0
    v_mfma_f32_16x16x32_bf16 v[84:87], v[100:103], v[164:167], 0
    s_add_u32 s43, s43, 1
    s_cmp_eq_u32 s43, 11
    s_cselect_b32 s43, 0, s43
    s_lshl_b32 s42, s43, 10
    s_add_u32 s42, s42, s20
    s_cmp_eq_u32 s43, s44
    s_cselect_b32 s42, 0x7000000, s42
    buffer_load_dwordx4 v[88:91], v8, s[24:27], s42 offen sc1
    s_add_u32 s42, s42, 44032
    buffer_load_dwordx4 v[92:95], v8, s[24:27], s42 offen sc1
    s_add_u32 s42, s42, 44032
    buffer_load_dwordx4 v[96:99], v8, s[24:27], s42 offen sc1
    s_add_u32 s42, s42, 44032
    buffer_load_dwordx4 v[100:103], v8, s[24:27], s42 offen sc1
    s_add_u32 s43, s43, 1
    s_cmp_eq_u32 s43, 11
    s_cselect_b32 s43, 0, s43
    s_lshl_b32 s42, s43, 10
    s_add_u32 s42, s42, s20
    s_cmp_eq_u32 s43, s44
    s_cselect_b32 s42, 0x7000000, s42
    buffer_load_dwordx4 v[152:155], v8, s[24:27], s42 offen sc1
    s_add_u32 s42, s42, 44032
    buffer_load_dwordx4 v[156:159], v8, s[24:27], s42 offen sc1
    s_add_u32 s42, s42, 44032
    buffer_load_dwordx4 v[160:163], v8, s[24:27], s42 offen sc1
    s_add_u32 s42, s42, 44032
    buffer_load_dwordx4 v[164:167], v8, s[24:27], s42 offen sc1
    s_waitcnt vmcnt(16)
    v_mfma_f32_16x16x32_bf16 v[24:27], v[104:107], v[168:171], v[24:27]
    v_mfma_f32_16x16x32_bf16 v[28:31], v[104:107], v[172:175], v[28:31]
    v_mfma_f32_16x16x32_bf16 v[32:35], v[104:107], v[176:179], v[32:35]
    v_mfma_f32_16x16x32_bf16 v[36:39], v[104:107], v[180:183], v[36:39]
    v_mfma_f32_16x16x32_bf16 v[40:43], v[108:111], v[168:171], v[40:43]
    v_mfma_f32_16x16x32_bf16 v[44:47], v[108:111], v[172:175], v[44:47]
    v_mfma_f32_16x16x32_bf16 v[48:51], v[108:111], v[176:179], v[48:51]
    v_mfma_f32_16x16x32_bf16 v[52:55], v[108:111], v[180:183], v[52:55]
    v_mfma_f32_16x16x32_bf16 v[56:59], v[112:115], v[168:171], v[56:59]
    v_mfma_f32_16x16x32_bf16 v[60:63], v[112:115], v[172:175], v[60:63]
    v_mfma_f32_16x16x32_bf16 v[64:67], v[112:115], v[176:179], v[64:67]
    v_mfma_f32_16x16x32_bf16 v[68:71], v[112:115], v[180:183], v[68:71]
    v_mfma_f32_16x16x32_bf16 v[72:75], v[116:119], v[168:171], v[72:75]
    v_mfma_f32_16x16x32_bf16 v[76:79], v[116:119], v[172:175], v[76:79]
    v_mfma_f32_16x16x32_bf16 v[80:83], v[116:119], v[176:179], v[80:83]
    v_mfma_f32_16x16x32_bf16 v[84:87], v[116:119], v[180:183], v[84:87]
    s_add_u32 s43, s43, 1
    s_cmp_eq_u32 s43, 11
    s_cselect_b32 s43, 0, s43
    s_lshl_b32 s42, s43, 10
    s_add_u32 s42, s42, s20
    s_cmp_eq_u32 s43, s44
    s_cselect_b32 s42, 0x7000000, s42
    buffer_load_dwordx4 v[104:107], v8, s[24:27], s42 offen sc1
    s_add_u32 s42, s42, 44032
    buffer_load_dwordx4 v[108:111], v8, s[24:27], s42 offen sc1
    s_add_u32 s42, s42, 44032
    buffer_load_dwordx4 v[112:115], v8, s[24:27], s42 offen sc1
    s_add_u32 s42, s42, 44032
    buffer_load_dwordx4 v[116:119], v8, s[24:27], s42 offen sc1
    s_add_u32 s43, s43, 1
    s_cmp_eq_u32 s43, 11
    s_cselect_b32 s43, 0, s43
    s_lshl_b32 s42, s43, 10
    s_add_u32 s42, s42, s20
    s_cmp_eq_u32 s43, s44
    s_cselect_b32 s42, 0x7000000, s42
    buffer_load_dwordx4 v[168:171], v8, s[24:27], s42 offen sc1
    s_add_u32 s42, s42, 44032
    buffer_load_dwordx4 v[172:175], v8, s[24:27], s42 offen sc1
    s_add_u32 s42, s42, 44032
    buffer_load_dwordx4 v[176:179], v8, s[24:27], s42 offen sc1
    s_add_u32 s42, s42, 44032
    buffer_load_dwordx4 v[180:183], v8, s[24:27], s42 offen sc1
    s_waitcnt vmcnt(20)
    v_mfma_f32_16x16x32_bf16 v[24:27], v[120:123], v[184:187], v[24:27]
    v_mfma_f32_16x16x32_bf16 v[28:31], v[120:123], v[188:191], v[28:31]
    v_mfma_f32_16x16x32_bf16 v[32:35], v[120:123], v[192:195], v[32:35]
    v_mfma_f32_16x16x32_bf16 v[36:39], v[120:123], v[196:199], v[36:39]
    v_mfma_f32_16x16x32_bf16 v[40:43], v[124:127], v[184:187], v[40:43]
    v_mfma_f32_16x16x32_bf16 v[44:47], v[124:127], v[188:191], v[44:47]
    v_mfma_f32_16x16x32_bf16 v[48:51], v[124:127], v[192:195], v[48:51]
    v_mfma_f32_16x16x32_bf16 v[52:55], v[124:127], v[196:199], v[52:55]
    v_mfma_f32_16x16x32_bf16 v[56:59], v[128:131], v[184:187], v[56:59]
    v_mfma_f32_16x16x32_bf16 v[60:63], v[128:131], v[188:191], v[60:63]
    v_mfma_f32_16x16x32_bf16 v[64:67], v[128:131], v[192:195], v[64:67]
    v_mfma_f32_16x16x32_bf16 v[68:71], v[128:131], v[196:199], v[68:71]
    v_mfma_f32_16x16x32_bf16 v[72:75], v[132:135], v[184:187], v[72:75]
    v_mfma_f32_16x16x32_bf16 v[76:79], v[132:135], v[188:191], v[76:79]
    v_mfma_f32_16x16x32_bf16 v[80:83], v[132:135], v[192:195], v[80:83]
    v_mfma_f32_16x16x32_bf16 v[84:87], v[132:135], v[196:199], v[84:87]
    s_add_u32 s43, s43, 1
    s_cmp_eq_u32 s43, 11
    s_cselect_b32 s43, 0, s43
    s_lshl_b32 s42, s43, 10
    s_add_u32 s42, s42, s20
    s_cmp_eq_u32 s43, s44
    s_cselect_b32 s42, 0x7000000, s42
    buffer_load_dwordx4 v[120:123], v8, s[24:27], s42 offen sc1
    s_add_u32 s42, s42, 44032
    buffer_load_dwordx4 v[124:127], v8, s[24:27], s42 offen sc1
    s_add_u32 s42, s42, 44032
    buffer_load_dwordx4 v[128:131], v8, s[24:27], s42 offen sc1
    s_add_u32 s42, s42, 44032
    buffer_load_dwordx4 v[132:135], v8, s[24:27], s42 offen sc1
    s_add_u32 s43, s43, 1
    s_cmp_eq_u32 s43, 11
    s_cselect_b32 s43, 0, s43
    s_lshl_b32 s42, s43, 10
    s_add_u32 s42, s42, s20
    s_cmp_eq_u32 s43, s44
    s_cselect_b32 s42, 0x7000000, s42
    buffer_load_dwordx4 v[184:187], v8, s[24:27], s42 offen sc1
    s_add_u32 s42, s42, 44032
    buffer_load_dwordx4 v[188:191], v8, s[24:27], s42 offen sc1
    s_add_u32 s42, s42, 44032
    buffer_load_dwordx4 v[192:195], v8, s[24:27], s42 offen sc1
    s_add_u32 s42, s42, 44032
    buffer_load_dwordx4 v[196:199], v8, s[24:27], s42 offen sc1
    s_waitcnt vmcnt(24)
    v_mfma_f32_16x16x32_bf16 v[24:27], v[136:139], v[200:203], v[24:27]
    v_mfma_f32_16x16x32_bf16 v[28:31], v[136:139], v[204:207], v[28:31]
    v_mfma_f32_16x16x32_bf16 v[32:35], v[136:139], v[208:211], v[32:35]
    v_mfma_f32_16x16x32_bf16 v[36:39], v[136:139], v[212:215], v[36:39]
    v_mfma_f32_16x16x32_bf16 v[40:43], v[140:143], v[200:203], v[40:43]
    v_mfma_f32_16x16x32_bf16 v[44:47], v[140:143], v[204:207], v[44:47]
    v_mfma_f32_16x16x32_bf16 v[48:51], v[140:143], v[208:211], v[48:51]
    v_mfma_f32_16x16x32_bf16 v[52:55], v[140:143], v[212:215], v[52:55]
    v_mfma_f32_16x16x32_bf16 v[56:59], v[144:147], v[200:203], v[56:59]
    v_mfma_f32_16x16x32_bf16 v[60:63], v[144:147], v[204:207], v[60:63]
    v_mfma_f32_16x16x32_bf16 v[64:67], v[144:147], v[208:211], v[64:67]
    v_mfma_f32_16x16x32_bf16 v[68:71], v[144:147], v[212:215], v[68:71]
    v_mfma_f32_16x16x32_bf16 v[72:75], v[148:151], v[200:203], v[72:75]
    v_mfma_f32_16x16x32_bf16 v[76:79], v[148:151], v[204:207], v[76:79]
    v_mfma_f32_16x16x32_bf16 v[80:83], v[148:151], v[208:211], v[80:83]
    v_mfma_f32_16x16x32_bf16 v[84:87], v[148:151], v[212:215], v[84:87]
    s_add_u32 s43, s43, 1
    s_cmp_eq_u32 s43, 11
    s_cselect_b32 s43, 0, s43
    s_lshl_b32 s42, s43, 10
    s_add_u32 s42, s42, s20
    s_cmp_eq_u32 s43, s44
    s_cselect_b32 s42, 0x7000000, s42
    buffer_load_dwordx4 v[136:139], v8, s[24:27], s42 offen sc1
    s_add_u32 s42, s42, 44032
    buffer_load_dwordx4 v[140:143], v8, s[24:27], s42 offen sc1
    s_add_u32 s42, s42, 44032
    buffer_load_dwordx4 v[144:147], v8, s[24:27], s42 offen sc1
    s_add_u32 s42, s42, 44032
    buffer_load_dwordx4 v[148:151], v8, s[24:27], s42 offen sc1
    ds_read_b64_tr_b16 v[200:201], v252 offset:8192
    ds_read_b64_tr_b16 v[202:203], v252 offset:9216
    ds_read_b64_tr_b16 v[204:205], v253 offset:8192
    ds_read_b64_tr_b16 v[206:207], v253 offset:9216
    ds_read_b64_tr_b16 v[208:209], v254 offset:8192
    ds_read_b64_tr_b16 v[210:211], v254 offset:9216
    ds_read_b64_tr_b16 v[212:213], v255 offset:8192
    ds_read_b64_tr_b16 v[214:215], v255 offset:9216
    s_waitcnt vmcnt(24)
    v_mfma_f32_16x16x32_bf16 v[24:27], v[88:91], v[216:219], v[24:27]
    v_mfma_f32_16x16x32_bf16 v[28:31], v[88:91], v[220:223], v[28:31]
    v_mfma_f32_16x16x32_bf16 v[32:35], v[88:91], v[224:227], v[32:35]
    v_mfma_f32_16x16x32_bf16 v[36:39], v[88:91], v[228:231], v[36:39]
    v_mfma_f32_16x16x32_bf16 v[40:43], v[92:95], v[216:219], v[40:43]
    v_mfma_f32_16x16x32_bf16 v[44:47], v[92:95], v[220:223], v[44:47]
    v_mfma_f32_16x16x32_bf16 v[48:51], v[92:95], v[224:227], v[48:51]
    v_mfma_f32_16x16x32_bf16 v[52:55], v[92:95], v[228:231], v[52:55]
    v_mfma_f32_16x16x32_bf16 v[56:59], v[96:99], v[216:219], v[56:59]
    v_mfma_f32_16x16x32_bf16 v[60:63], v[96:99], v[220:223], v[60:63]
    v_mfma_f32_16x16x32_bf16 v[64:67], v[96:99], v[224:227], v[64:67]
    v_mfma_f32_16x16x32_bf16 v[68:71], v[96:99], v[228:231], v[68:71]
    v_mfma_f32_16x16x32_bf16 v[72:75], v[100:103], v[216:219], v[72:75]
    v_mfma_f32_16x16x32_bf16 v[76:79], v[100:103], v[220:223], v[76:79]
    v_mfma_f32_16x16x32_bf16 v[80:83], v[100:103], v[224:227], v[80:83]
    v_mfma_f32_16x16x32_bf16 v[84:87], v[100:103], v[228:231], v[84:87]
    ds_read_b64_tr_b16 v[88:89], v252 offset:12288
    ds_read_b64_tr_b16 v[90:91], v252 offset:13312
    ds_read_b64_tr_b16 v[92:93], v253 offset:12288
    ds_read_b64_tr_b16 v[94:95], v253 offset:13312
    ds_read_b64_tr_b16 v[96:97], v254 offset:12288
    ds_read_b64_tr_b16 v[98:99], v254 offset:13312
    ds_read_b64_tr_b16 v[100:101], v255 offset:12288
    ds_read_b64_tr_b16 v[102:103], v255 offset:13312
    ds_read_b64_tr_b16 v[216:217], v252 offset:16384
    ds_read_b64_tr_b16 v[218:219], v252 offset:17408
    ds_read_b64_tr_b16 v[220:221], v253 offset:16384
    ds_read_b64_tr_b16 v[222:223], v253 offset:17408
    ds_read_b64_tr_b16 v[224:225], v254 offset:16384
    ds_read_b64_tr_b16 v[226:227], v254 offset:17408
    ds_read_b64_tr_b16 v[228:229], v255 offset:16384
    ds_read_b64_tr_b16 v[230:231], v255 offset:17408
    s_waitcnt vmcnt(20)
    v_mfma_f32_16x16x32_bf16 v[24:27], v[152:155], v[232:235], v[24:27]
    v_mfma_f32_16x16x32_bf16 v[28:31], v[152:155], v[236:239], v[28:31]
    v_mfma_f32_16x16x32_bf16 v[32:35], v[152:155], v[240:243], v[32:35]
    v_mfma_f32_16x16x32_bf16 v[36:39], v[152:155], v[244:247], v[36:39]
    v_mfma_f32_16x16x32_bf16 v[40:43], v[156:159], v[232:235], v[40:43]
    v_mfma_f32_16x16x32_bf16 v[44:47], v[156:159], v[236:239], v[44:47]
    v_mfma_f32_16x16x32_bf16 v[48:51], v[156:159], v[240:243], v[48:51]
    v_mfma_f32_16x16x32_bf16 v[52:55], v[156:159], v[244:247], v[52:55]
    v_mfma_f32_16x16x32_bf16 v[56:59], v[160:163], v[232:235], v[56:59]
    v_mfma_f32_16x16x32_bf16 v[60:63], v[160:163], v[236:239], v[60:63]
    v_mfma_f32_16x16x32_bf16 v[64:67], v[160:163], v[240:243], v[64:67]
    v_mfma_f32_16x16x32_bf16 v[68:71], v[160:163], v[244:247], v[68:71]
    v_mfma_f32_16x16x32_bf16 v[72:75], v[164:167], v[232:235], v[72:75]
    v_mfma_f32_16x16x32_bf16 v[76:79], v[164:167], v[236:239], v[76:79]
    v_mfma_f32_16x16x32_bf16 v[80:83], v[164:167], v[240:243], v[80:83]
    v_mfma_f32_16x16x32_bf16 v[84:87], v[164:167], v[244:247], v[84:87]
    s_waitcnt vmcnt(16)
    s_waitcnt lgkmcnt(0)
    v_mfma_f32_16x16x32_bf16 v[24:27], v[104:107], v[200:203], v[24:27]
    v_mfma_f32_16x16x32_bf16 v[28:31], v[104:107], v[204:207], v[28:31]
    v_mfma_f32_16x16x32_bf16 v[32:35], v[104:107], v[208:211], v[32:35]
    v_mfma_f32_16x16x32_bf16 v[36:39], v[104:107], v[212:215], v[36:39]
    v_mfma_f32_16x16x32_bf16 v[40:43], v[108:111], v[200:203], v[40:43]
    v_mfma_f32_16x16x32_bf16 v[44:47], v[108:111], v[204:207], v[44:47]
    v_mfma_f32_16x16x32_bf16 v[48:51], v[108:111], v[208:211], v[48:51]
    v_mfma_f32_16x16x32_bf16 v[52:55], v[108:111], v[212:215], v[52:55]
    v_mfma_f32_16x16x32_bf16 v[56:59], v[112:115], v[200:203], v[56:59]
    v_mfma_f32_16x16x32_bf16 v[60:63], v[112:115], v[204:207], v[60:63]
    v_mfma_f32_16x16x32_bf16 v[64:67], v[112:115], v[208:211], v[64:67]
    v_mfma_f32_16x16x32_bf16 v[68:71], v[112:115], v[212:215], v[68:71]
    v_mfma_f32_16x16x32_bf16 v[72:75], v[116:119], v[200:203], v[72:75]
    v_mfma_f32_16x16x32_bf16 v[76:79], v[116:119], v[204:207], v[76:79]
    v_mfma_f32_16x16x32_bf16 v[80:83], v[116:119], v[208:211], v[80:83]
    v_mfma_f32_16x16x32_bf16 v[84:87], v[116:119], v[212:215], v[84:87]
    ds_read_b64_tr_b16 v[152:153], v252 offset:0
    ds_read_b64_tr_b16 v[154:155], v252 offset:1024
    ds_read_b64_tr_b16 v[156:157], v253 offset:0
    ds_read_b64_tr_b16 v[158:159], v253 offset:1024
    ds_read_b64_tr_b16 v[160:161], v254 offset:0
    ds_read_b64_tr_b16 v[162:163], v254 offset:1024
    ds_read_b64_tr_b16 v[164:165], v255 offset:0
    ds_read_b64_tr_b16 v[166:167], v255 offset:1024
    ds_read_b64_tr_b16 v[232:233], v252 offset:4096
    ds_read_b64_tr_b16 v[234:235], v252 offset:5120
    ds_read_b64_tr_b16 v[236:237], v253 offset:4096
    ds_read_b64_tr_b16 v[238:239], v253 offset:5120
    ds_read_b64_tr_b16 v[240:241], v254 offset:4096
    ds_read_b64_tr_b16 v[242:243], v254 offset:5120
    ds_read_b64_tr_b16 v[244:245], v255 offset:4096
    ds_read_b64_tr_b16 v[246:247], v255 offset:5120
    s_waitcnt vmcnt(12)
    v_mfma_f32_16x16x32_bf16 v[24:27], v[168:171], v[88:91], v[24:27]
    v_mfma_f32_16x16x32_bf16 v[28:31], v[168:171], v[92:95], v[28:31]
    v_mfma_f32_16x16x32_bf16 v[32:35], v[168:171], v[96:99], v[32:35]
    v_mfma_f32_16x16x32_bf16 v[36:39], v[168:171], v[100:103], v[36:39]
    v_mfma_f32_16x16x32_bf16 v[40:43], v[172:175], v[88:91], v[40:43]
    v_mfma_f32_16x16x32_bf16 v[44:47], v[172:175], v[92:95], v[44:47]
    v_mfma_f32_16x16x32_bf16 v[48:51], v[172:175], v[96:99], v[48:51]
    v_mfma_f32_16x16x32_bf16 v[52:55], v[172:175], v[100:103], v[52:55]
    v_mfma_f32_16x16x32_bf16 v[56:59], v[176:179], v[88:91], v[56:59]
    v_mfma_f32_16x16x32_bf16 v[60:63], v[176:179], v[92:95], v[60:63]
    v_mfma_f32_16x16x32_bf16 v[64:67], v[176:179], v[96:99], v[64:67]
    v_mfma_f32_16x16x32_bf16 v[68:71], v[176:179], v[100:103], v[68:71]
    v_mfma_f32_16x16x32_bf16 v[72:75], v[180:183], v[88:91], v[72:75]
    v_mfma_f32_16x16x32_bf16 v[76:79], v[180:183], v[92:95], v[76:79]
    v_mfma_f32_16x16x32_bf16 v[80:83], v[180:183], v[96:99], v[80:83]
    v_mfma_f32_16x16x32_bf16 v[84:87], v[180:183], v[100:103], v[84:87]
    s_waitcnt vmcnt(8)
    v_mfma_f32_16x16x32_bf16 v[24:27], v[120:123], v[216:219], v[24:27]
    v_mfma_f32_16x16x32_bf16 v[28:31], v[120:123], v[220:223], v[28:31]
    v_mfma_f32_16x16x32_bf16 v[32:35], v[120:123], v[224:227], v[32:35]
    v_mfma_f32_16x16x32_bf16 v[36:39], v[120:123], v[228:231], v[36:39]
    v_mfma_f32_16x16x32_bf16 v[40:43], v[124:127], v[216:219], v[40:43]
    v_mfma_f32_16x16x32_bf16 v[44:47], v[124:127], v[220:223], v[44:47]
    v_mfma_f32_16x16x32_bf16 v[48:51], v[124:127], v[224:227], v[48:51]
    v_mfma_f32_16x16x32_bf16 v[52:55], v[124:127], v[228:231], v[52:55]
    v_mfma_f32_16x16x32_bf16 v[56:59], v[128:131], v[216:219], v[56:59]
    v_mfma_f32_16x16x32_bf16 v[60:63], v[128:131], v[220:223], v[60:63]
    v_mfma_f32_16x16x32_bf16 v[64:67], v[128:131], v[224:227], v[64:67]
    v_mfma_f32_16x16x32_bf16 v[68:71], v[128:131], v[228:231], v[68:71]
    v_mfma_f32_16x16x32_bf16 v[72:75], v[132:135], v[216:219], v[72:75]
    v_mfma_f32_16x16x32_bf16 v[76:79], v[132:135], v[220:223], v[76:79]
    v_mfma_f32_16x16x32_bf16 v[80:83], v[132:135], v[224:227], v[80:83]
    v_mfma_f32_16x16x32_bf16 v[84:87], v[132:135], v[228:231], v[84:87]
    s_waitcnt vmcnt(4)
    s_waitcnt lgkmcnt(0)
    v_mfma_f32_16x16x32_bf16 v[24:27], v[184:187], v[152:155], v[24:27]
    v_mfma_f32_16x16x32_bf16 v[28:31], v[184:187], v[156:159], v[28:31]
    v_mfma_f32_16x16x32_bf16 v[32:35], v[184:187], v[160:163], v[32:35]
    v_mfma_f32_16x16x32_bf16 v[36:39], v[184:187], v[164:167], v[36:39]
    v_mfma_f32_16x16x32_bf16 v[40:43], v[188:191], v[152:155], v[40:43]
    v_mfma_f32_16x16x32_bf16 v[44:47], v[188:191], v[156:159], v[44:47]
    v_mfma_f32_16x16x32_bf16 v[48:51], v[188:191], v[160:163], v[48:51]
    v_mfma_f32_16x16x32_bf16 v[52:55], v[188:191], v[164:167], v[52:55]
    v_mfma_f32_16x16x32_bf16 v[56:59], v[192:195], v[152:155], v[56:59]
    v_mfma_f32_16x16x32_bf16 v[60:63], v[192:195], v[156:159], v[60:63]
    v_mfma_f32_16x16x32_bf16 v[64:67], v[192:195], v[160:163], v[64:67]
    v_mfma_f32_16x16x32_bf16 v[68:71], v[192:195], v[164:167], v[68:71]
    v_mfma_f32_16x16x32_bf16 v[72:75], v[196:199], v[152:155], v[72:75]
    v_mfma_f32_16x16x32_bf16 v[76:79], v[196:199], v[156:159], v[76:79]
    v_mfma_f32_16x16x32_bf16 v[80:83], v[196:199], v[160:163], v[80:83]
    v_mfma_f32_16x16x32_bf16 v[84:87], v[196:199], v[164:167], v[84:87]
    s_waitcnt vmcnt(0)
    v_mfma_f32_16x16x32_bf16 v[24:27], v[136:139], v[232:235], v[24:27]
    v_mfma_f32_16x16x32_bf16 v[28:31], v[136:139], v[236:239], v[28:31]
    v_mfma_f32_16x16x32_bf16 v[32:35], v[136:139], v[240:243], v[32:35]
    v_mfma_f32_16x16x32_bf16 v[36:39], v[136:139], v[244:247], v[36:39]
    v_mfma_f32_16x16x32_bf16 v[40:43], v[140:143], v[232:235], v[40:43]
    v_mfma_f32_16x16x32_bf16 v[44:47], v[140:143], v[236:239], v[44:47]
    v_mfma_f32_16x16x32_bf16 v[48:51], v[140:143], v[240:243], v[48:51]
    v_mfma_f32_16x16x32_bf16 v[52:55], v[140:143], v[244:247], v[52:55]
    v_mfma_f32_16x16x32_bf16 v[56:59], v[144:147], v[232:235], v[56:59]
    v_mfma_f32_16x16x32_bf16 v[60:63], v[144:147], v[236:239], v[60:63]
    v_mfma_f32_16x16x32_bf16 v[64:67], v[144:147], v[240:243], v[64:67]
    v_mfma_f32_16x16x32_bf16 v[68:71], v[144:147], v[244:247], v[68:71]
    v_mfma_f32_16x16x32_bf16 v[72:75], v[148:151], v[232:235], v[72:75]
    v_mfma_f32_16x16x32_bf16 v[76:79], v[148:151], v[236:239], v[76:79]
    v_mfma_f32_16x16x32_bf16 v[80:83], v[148:151], v[240:243], v[80:83]
    v_mfma_f32_16x16x32_bf16 v[84:87], v[148:151], v[244:247], v[84:87]
    s_mul_i32 s23, s3, 20480
    v_add_u32 v5, s23, v8
    ds_write_b128 v5, v[24:27] offset:0
    ds_write_b128 v5, v[28:31] offset:1024
    ds_write_b128 v5, v[32:35] offset:2048
    ds_write_b128 v5, v[36:39] offset:3072
    ds_write_b128 v5, v[40:43] offset:4096
    ds_write_b128 v5, v[44:47] offset:5120
    ds_write_b128 v5, v[48:51] offset:6144
    ds_write_b128 v5, v[52:55] offset:7168
    ds_write_b128 v5, v[56:59] offset:8192
    ds_write_b128 v5, v[60:63] offset:9216
    ds_write_b128 v5, v[64:67] offset:10240
    ds_write_b128 v5, v[68:71] offset:11264
    ds_write_b128 v5, v[72:75] offset:12288
    ds_write_b128 v5, v[76:79] offset:13312
    ds_write_b128 v5, v[80:83] offset:14336
    ds_write_b128 v5, v[84:87] offset:15360
    v_lshlrev_b32 v6, 12, v2
    v_lshl_add_u32 v6, v3, 4, v6
    s_lshl_b32 s23, s3, 10
    v_add_u32 v6, s23, v6
    v_lshlrev_b32 v10, 16, v11
    v_lshlrev_b32 v160, 16, v16
    v_and_b32 v161, 0xffff0000, v16
    v_lshlrev_b32 v162, 16, v17
    v_and_b32 v163, 0xffff0000, v17
    v_lshlrev_b32 v164, 16, v18
    v_and_b32 v165, 0xffff0000, v18
    v_lshlrev_b32 v166, 16, v19
    v_and_b32 v167, 0xffff0000, v19
    v_lshlrev_b32 v168, 16, v20
    v_and_b32 v169, 0xffff0000, v20
    v_lshlrev_b32 v170, 16, v21
    v_and_b32 v171, 0xffff0000, v21
    v_lshlrev_b32 v172, 16, v22
    v_and_b32 v173, 0xffff0000, v22
    v_lshlrev_b32 v174, 16, v23
    v_and_b32 v175, 0xffff0000, v23
    s_waitcnt lgkmcnt(0)
    s_barrier
    ds_read_b128 v[88:91], v6 offset:0
    ds_read_b128 v[92:95], v6 offset:20480
    ds_read_b128 v[96:99], v6 offset:40960
    ds_read_b128 v[100:103], v6 offset:61440
    ds_read_b128 v[104:107], v6 offset:256
    ds_read_b128 v[108:111], v6 offset:20736
    ds_read_b128 v[112:115], v6 offset:41216
    ds_read_b128 v[116:119], v6 offset:61696
    ds_read_b128 v[120:123], v6 offset:512
    ds_read_b128 v[124:127], v6 offset:20992
    ds_read_b128 v[128:131], v6 offset:41472
    ds_read_b128 v[132:135], v6 offset:61952
    ds_read_b128 v[136:139], v6 offset:768
    ds_read_b128 v[140:143], v6 offset:21248
    ds_read_b128 v[144:147], v6 offset:41728
    ds_read_b128 v[148:151], v6 offset:62208
    s_waitcnt lgkmcnt(12)
    v_pk_add_f32 v[88:89], v[88:89], v[92:93]
    v_pk_add_f32 v[96:97], v[96:97], v[100:101]
    v_pk_add_f32 v[90:91], v[90:91], v[94:95]
    v_pk_add_f32 v[98:99], v[98:99], v[102:103]
    v_pk_add_f32 v[88:89], v[88:89], v[96:97]
    v_pk_add_f32 v[90:91], v[90:91], v[98:99]
    v_cvt_pk_bf16_f32 v48, v88, v89
    v_cvt_pk_bf16_f32 v49, v90, v91
    v_lshlrev_b32 v88, 16, v48
    v_and_b32 v89, 0xffff0000, v48
    v_lshlrev_b32 v90, 16, v49
    v_and_b32 v91, 0xffff0000, v49
    v_pk_add_f32 v[88:89], v[88:89], v[10:11] op_sel_hi:[1,0]
    v_pk_add_f32 v[90:91], v[90:91], v[10:11] op_sel_hi:[1,0]
    v_cvt_pk_bf16_f32 v48, v88, v89
    v_cvt_pk_bf16_f32 v49, v90, v91
    v_lshlrev_b32 v88, 16, v48
    v_and_b32 v89, 0xffff0000, v48
    v_lshlrev_b32 v90, 16, v49
    v_and_b32 v91, 0xffff0000, v49
    v_pk_add_f32 v[88:89], v[88:89], v[160:161]
    v_pk_add_f32 v[90:91], v[90:91], v[162:163]
    v_cvt_pk_bf16_f32 v40, v88, v89
    v_cvt_pk_bf16_f32 v41, v90, v91
    s_waitcnt lgkmcnt(8)
    v_pk_add_f32 v[104:105], v[104:105], v[108:109]
    v_pk_add_f32 v[112:113], v[112:113], v[116:117]
    v_pk_add_f32 v[106:107], v[106:107], v[110:111]
    v_pk_add_f32 v[114:115], v[114:115], v[118:119]
    v_pk_add_f32 v[104:105], v[104:105], v[112:113]
    v_pk_add_f32 v[106:107], v[106:107], v[114:115]
    v_cvt_pk_bf16_f32 v48, v104, v105
    v_cvt_pk_bf16_f32 v49, v106, v107
    v_lshlrev_b32 v104, 16, v48
    v_and_b32 v105, 0xffff0000, v48
    v_lshlrev_b32 v106, 16, v49
    v_and_b32 v107, 0xffff0000, v49
    v_pk_add_f32 v[104:105], v[104:105], v[10:11] op_sel_hi:[1,0]
    v_pk_add_f32 v[106:107], v[106:107], v[10:11] op_sel_hi:[1,0]
    v_cvt_pk_bf16_f32 v48, v104, v105
    v_cvt_pk_bf16_f32 v49, v106, v107
    v_lshlrev_b32 v104, 16, v48
    v_and_b32 v105, 0xffff0000, v48
    v_lshlrev_b32 v106, 16, v49
    v_and_b32 v107, 0xffff0000, v49
    v_pk_add_f32 v[104:105], v[104:105], v[164:165]
    v_pk_add_f32 v[106:107], v[106:107], v[166:167]
    v_cvt_pk_bf16_f32 v42, v104, v105
    v_cvt_pk_bf16_f32 v43, v106, v107
    buffer_store_dwordx4 v[40:43], v9, s[36:39], s22 offen offset:0
    s_waitcnt lgkmcnt(4)
    v_pk_add_f32 v[120:121], v[120:121], v[124:125]
    v_pk_add_f32 v[128:129], v[128:129], v[132:133]
    v_pk_add_f32 v[122:123], v[122:123], v[126:127]
    v_pk_add_f32 v[130:131], v[130:131], v[134:135]
    v_pk_add_f32 v[120:121], v[120:121], v[128:129]
    v_pk_add_f32 v[122:123], v[122:123], v[130:131]
    v_cvt_pk_bf16_f32 v48, v120, v121
    v_cvt_pk_bf16_f32 v49, v122, v123
    v_lshlrev_b32 v120, 16, v48
    v_and_b32 v121, 0xffff0000, v48
    v_lshlrev_b32 v122, 16, v49
    v_and_b32 v123, 0xffff0000, v49
    v_pk_add_f32 v[120:121], v[120:121], v[10:11] op_sel_hi:[1,0]
    v_pk_add_f32 v[122:123], v[122:123], v[10:11] op_sel_hi:[1,0]
    v_cvt_pk_bf16_f32 v48, v120, v121
    v_cvt_pk_bf16_f32 v49, v122, v123
    v_lshlrev_b32 v120, 16, v48
    v_and_b32 v121, 0xffff0000, v48
    v_lshlrev_b32 v122, 16, v49
    v_and_b32 v123, 0xffff0000, v49
    v_pk_add_f32 v[120:121], v[120:121], v[168:169]
    v_pk_add_f32 v[122:123], v[122:123], v[170:171]
    v_cvt_pk_bf16_f32 v44, v120, v121
    v_cvt_pk_bf16_f32 v45, v122, v123
    s_waitcnt lgkmcnt(0)
    v_pk_add_f32 v[136:137], v[136:137], v[140:141]
    v_pk_add_f32 v[144:145], v[144:145], v[148:149]
    v_pk_add_f32 v[138:139], v[138:139], v[142:143]
    v_pk_add_f32 v[146:147], v[146:147], v[150:151]
    v_pk_add_f32 v[136:137], v[136:137], v[144:145]
    v_pk_add_f32 v[138:139], v[138:139], v[146:147]
    v_cvt_pk_bf16_f32 v48, v136, v137
    v_cvt_pk_bf16_f32 v49, v138, v139
    v_lshlrev_b32 v136, 16, v48
    v_and_b32 v137, 0xffff0000, v48
    v_lshlrev_b32 v138, 16, v49
    v_and_b32 v139, 0xffff0000, v49
    v_pk_add_f32 v[136:137], v[136:137], v[10:11] op_sel_hi:[1,0]
    v_pk_add_f32 v[138:139], v[138:139], v[10:11] op_sel_hi:[1,0]
    v_cvt_pk_bf16_f32 v48, v136, v137
    v_cvt_pk_bf16_f32 v49, v138, v139
    v_lshlrev_b32 v136, 16, v48
    v_and_b32 v137, 0xffff0000, v48
    v_lshlrev_b32 v138, 16, v49
    v_and_b32 v139, 0xffff0000, v49
    v_pk_add_f32 v[136:137], v[136:137], v[172:173]
    v_pk_add_f32 v[138:139], v[138:139], v[174:175]
    v_cvt_pk_bf16_f32 v46, v136, v137
    v_cvt_pk_bf16_f32 v47, v138, v139
    buffer_store_dwordx4 v[44:47], v9, s[36:39], s22 offen offset:16
K5_END:
    s_endpgm

CODE_END:
.section .rodata,"a"
.p2align 6
.amdhsa_kernel k1_kernel
  .amdhsa_next_free_vgpr 176
  .amdhsa_next_free_sgpr 64
  .amdhsa_accum_offset 176
  .amdhsa_group_segment_fixed_size 0
  .amdhsa_kernarg_size 88
  .amdhsa_user_sgpr_count 2
  .amdhsa_user_sgpr_kernarg_segment_ptr 1
  .amdhsa_system_sgpr_workgroup_id_x 1
.end_amdhsa_kernel
.p2align 6
.amdhsa_kernel k2_kernel
  .amdhsa_next_free_vgpr 256
  .amdhsa_next_free_sgpr 64
  .amdhsa_accum_offset 256
  .amdhsa_group_segment_fixed_size 0
  .amdhsa_kernarg_size 88
  .amdhsa_user_sgpr_count 2
  .amdhsa_user_sgpr_kernarg_segment_ptr 1
  .amdhsa_system_sgpr_workgroup_id_x 1
.end_amdhsa_kernel
.p2align 6
.amdhsa_kernel k3_kernel
  .amdhsa_next_free_vgpr 152
  .amdhsa_next_free_sgpr 64
  .amdhsa_accum_offset 152
  .amdhsa_group_segment_fixed_size 0
  .amdhsa_kernarg_size 88
  .amdhsa_user_sgpr_count 2
  .amdhsa_user_sgpr_kernarg_segment_ptr 1
  .amdhsa_system_sgpr_workgroup_id_x 1
.end_amdhsa_kernel
.p2align 6
.amdhsa_kernel sequential_preLN__spectral_gfnet__mixer_token_mlp__prompt_kernel
  .amdhsa_next_free_vgpr 256
  .amdhsa_next_free_sgpr 64
  .amdhsa_accum_offset 256
  .amdhsa_group_segment_fixed_size 0
  .amdhsa_kernarg_size 88
  .amdhsa_user_sgpr_count 2
  .amdhsa_user_sgpr_kernarg_segment_ptr 1
  .amdhsa_system_sgpr_workgroup_id_x 1
.end_amdhsa_kernel
```
